```python
import torch

def _softmax(x, axis=-1):
    return torch.softmax(x, dim=axis)
def _gelu(x):
    return torch.nn.functional.gelu(x, approximate="tanh")
def _silu(x):
    return torch.nn.functional.silu(x)
def _sigmoid(x):
    return torch.sigmoid(x)
def _layernorm(x, axis=-1, eps=1e-5):
    m = x.mean(dim=axis, keepdim=True)
    v = x.var(dim=axis, keepdim=True, unbiased=False)
    return (x - m) / torch.sqrt(v + eps)
def _scatter_add(tgt, idx, src, axis=0):
    return tgt.clone().index_add_(axis, idx, src)
def _segment_sum(src, seg, n):
    out = torch.zeros((n,) + src.shape[1:], dtype=src.dtype)
    return out.index_add_(0, seg, src)
def _pad(x, pw):
    flat = tuple(v for pair in reversed(pw) for v in pair)
    return torch.nn.functional.pad(x, flat)

kernel_name = 'standalone__gqa_block_cached__sampling'

def setup_inputs():

    _w = (lambda a: (lambda t: t.to(torch.bfloat16) if t.is_floating_point() else t)(torch.as_tensor(a)))
    B, Sq, D = 32, 32, 576
    Hq, Hkv, Sk, Dh = 32, 16, 2048, 128
    assert Hq % Hkv == 0, (Hq, Hkv)
    return {
        "x": _w((lambda *s: torch.randn(*s, dtype=torch.bfloat16) * 0.8)(B, Sq, D)),
        "k_cache": _w((lambda *s: torch.randn(*s, dtype=torch.bfloat16) * 0.8)(B, Hkv, Sk, Dh)),
        "v_cache": _w((lambda *s: torch.randn(*s, dtype=torch.bfloat16) * 0.05)(B, Hkv, Sk, Dh)),
        "wq": _w((lambda *s: torch.randn(*s, dtype=torch.bfloat16) * 0.8)(D, Hq * Dh) * (D ** -0.5)),
        "wo": _w((lambda *s: torch.randn(*s, dtype=torch.bfloat16) * 0.05)(Hq * Dh, D) * ((Hq * Dh) ** -0.5)),
    }

def reference(x, k_cache, v_cache, wq, wo):
    B, Sq, D = x.shape
    Hq, Dh = 32, 128
    Hkv = k_cache.shape[1]
    rep = Hq // Hkv
    q = (lambda x, *d: x.permute(*d))((x @ wq).reshape(B, Sq, Hq, Dh), 0, 2, 1, 3)
    k = (lambda x, n, axis: torch.repeat_interleave(x, n, dim=axis))(k_cache, rep, axis=1)
    v = (lambda x, n, axis: torch.repeat_interleave(x, n, dim=axis))(v_cache, rep, axis=1)
    scores = torch.einsum("bhqd,bhkd->bhqk", q, k) * (Dh ** -0.5)
    p = _softmax(scores, axis=-1)
    o = torch.einsum("bhqk,bhkd->bhqd", p, v)
    return (lambda x, *d: x.permute(*d))(o, 0, 2, 1, 3).reshape(B, Sq, Hq * Dh) @ wo
```

```asm
; @launch grid=(256,1,1) block=(256,1,1) lds=163840
.amdgcn_target "amdgcn-amd-amdhsa--gfx950"
.text
.globl standalone__gqa_block_cached__sampling_kernel
.p2align 8
.type standalone__gqa_block_cached__sampling_kernel,@function
standalone__gqa_block_cached__sampling_kernel:
    s_cmp_ge_u32 s2, 256
    s_cbranch_scc1 L_done
    s_load_dwordx8 s[60:67], s[0:1], 0
    s_load_dwordx2 s[68:69], s[0:1], 32
    s_load_dwordx2 s[70:71], s[0:1], 56
    s_load_dwordx4 s[88:91], s[0:1], 40
    s_memrealtime s[94:95]
    v_lshrrev_b32 v32, 6, v0
    v_and_b32 v31, 63, v0
    v_readfirstlane_b32 s28, v32
    s_and_b32 s92, s2, 7
    s_lshr_b32 s93, s2, 3
    s_mov_b32 s14, 4718592
    s_mov_b32 s15, 0x20000
    s_lshl_b32 s36, s93, 2
    s_add_u32 s36, s36, s28
    s_mul_i32 s36, s36, 18
    v_add_u32 v40, s36, v31
    s_lshl_b32 s39, s92, 10
    v_lshrrev_b32 v41, 2, v40
    v_and_b32 v42, 3, v40
    v_lshlrev_b32 v42, 7, v42
    v_lshl_add_u32 v41, v41, 13, v42
    v_lshrrev_b32 v33, 4, v31
    v_and_b32 v34, 15, v31
    v_xor_b32 v35, v34, v33
    v_lshlrev_b32 v35, 4, v35
    v_mul_u32_u24 v36, 1152, v33
    v_add_u32 v44, v36, v35
    v_xor_b32 v45, 64, v35
    v_add_u32 v45, v36, v45
    v_xor_b32 v46, 128, v35
    v_add_u32 v46, v36, v46
    v_xor_b32 v47, 192, v35
    v_add_u32 v47, v36, v47
    s_mov_b32 s22, 1179648
    s_mov_b32 s23, 0x20000
    s_lshl_b32 s49, s28, 13
    s_mov_b32 s33, s49
    s_add_u32 s49, s49, 131072
    s_mul_i32 s40, s93, 36864
    s_add_u32 s56, s40, 1024
    s_lshl_b32 s36, s28, 8
    s_add_u32 s40, s40, s36
    s_waitcnt lgkmcnt(0)
    s_mov_b32 s12, s66
    s_mov_b32 s13, s67
    s_mov_b32 s20, s60
    s_mov_b32 s21, s61
    s_mov_b64 exec, 0x3ffff
    buffer_load_dword v30, v41, s[12:15], s39 offen nt
    buffer_load_dword v30, v41, s[12:15], s39 offen
    s_mov_b64 exec, -1
    s_mov_b32 m0, s49
    s_add_u32 s35, s40, 0
    buffer_load_dwordx4 v44, s[20:23], s35 offen offset:0  lds
    s_add_u32 s35, s40, 3584
    buffer_load_dwordx4 v45, s[20:23], s35 offen offset:1024  lds
    s_add_u32 s35, s40, 7168
    buffer_load_dwordx4 v46, s[20:23], s35 offen offset:2048  lds
    s_add_u32 s35, s40, 10752
    buffer_load_dwordx4 v47, s[20:23], s35 offen offset:3072  lds
    s_add_u32 m0, s49, 4096
    s_add_u32 s35, s40, 18432
    buffer_load_dwordx4 v44, s[20:23], s35 offen offset:0  lds
    s_add_u32 s35, s40, 22016
    buffer_load_dwordx4 v45, s[20:23], s35 offen offset:1024  lds
    s_add_u32 s35, s40, 25600
    buffer_load_dwordx4 v46, s[20:23], s35 offen offset:2048  lds
    s_add_u32 s35, s40, 29184
    buffer_load_dwordx4 v47, s[20:23], s35 offen offset:3072  lds
    v_lshrrev_b32 v38, 3, v31
    v_and_b32 v37, 1, v33
    v_lshlrev_b32 v37, 2, v37
    v_and_b32 v39, 7, v31
    v_xor_b32 v37, v37, v39
    v_lshlrev_b32 v37, 4, v37
    v_lshl_add_u32 v7, v38, 13, v37
    v_mul_u32_u24 v38, 1152, v38
    v_add_u32 v9, v38, v37
    s_lshl_b32 s31, s28, 15
    s_add_u32 s32, s31, 24576
    s_mov_b32 s38, s32
    s_mov_b32 m0, s38
    s_add_u32 s35, s56, 0
    buffer_load_dwordx4 v9, s[20:23], s35 offen offset:0  lds
    s_add_u32 s35, s56, 8192
    buffer_load_dwordx4 v9, s[20:23], s35 offen offset:1024  lds
    s_add_u32 s35, s56, 16384
    buffer_load_dwordx4 v9, s[20:23], s35 offen offset:2048  lds
    s_add_u32 s35, s56, 24576
    buffer_load_dwordx4 v9, s[20:23], s35 offen offset:3072  lds
    s_add_u32 s52, s31, 8192
    s_add_u32 s53, s31, 16384
    v_lshl_add_u32 v2, v33, 8, v35
    v_xor_b32 v3, 64, v2
    v_xor_b32 v4, 128, v2
    v_xor_b32 v5, 192, v2
    v_lshlrev_b32 v35, 2, v33
    v_xor_b32 v35, v34, v35
    v_lshlrev_b32 v35, 4, v35
    v_lshl_add_u32 v6, v33, 8, v35
    v_add_u32 v8, v36, v35
    s_mov_b32 s86, 4096
    s_mov_b32 s87, 32768
    s_mov_b32 s34, s33
    s_lshl_b32 s72, s2, 20
    s_lshr_b32 s73, s2, 12
    s_mov_b32 s6, 1048576
    s_mov_b32 s7, 0x20000
    s_mov_b32 s10, 1048576
    s_mov_b32 s11, 0x20000
    s_add_u32 s4, s62, s72
    s_addc_u32 s5, s63, s73
    s_add_u32 s8, s64, s72
    s_addc_u32 s9, s65, s73
    s_lshl_b32 s35, s28, 7
    s_add_u32 s39, s39, s35
    s_lshr_b32 s59, 2863311530, s93
    s_and_b32 s59, s59, 1
    s_cbranch_scc0 L_pB0
    s_mov_b32 m0, s52
    s_add_u32 s35, s33, s86
    buffer_load_dwordx4 v2, s[4:7], s33 offen offset:0 nt lds
    buffer_load_dwordx4 v3, s[4:7], s33 offen offset:1024 nt lds
    buffer_load_dwordx4 v4, s[4:7], s33 offen offset:2048 nt lds
    buffer_load_dwordx4 v5, s[4:7], s33 offen offset:3072 nt lds
    s_add_u32 m0, s52, 4096
    s_add_u32 s33, s33, s87
    buffer_load_dwordx4 v2, s[4:7], s35 offen offset:0 nt lds
    buffer_load_dwordx4 v3, s[4:7], s35 offen offset:1024 nt lds
    buffer_load_dwordx4 v4, s[4:7], s35 offen offset:2048 nt lds
    buffer_load_dwordx4 v5, s[4:7], s35 offen offset:3072 nt lds
    s_mov_b32 m0, s53
    s_add_u32 s35, s33, s86
    buffer_load_dwordx4 v2, s[4:7], s33 offen offset:0 nt lds
    buffer_load_dwordx4 v3, s[4:7], s33 offen offset:1024 nt lds
    buffer_load_dwordx4 v4, s[4:7], s33 offen offset:2048 nt lds
    buffer_load_dwordx4 v5, s[4:7], s33 offen offset:3072 nt lds
    s_add_u32 m0, s53, 4096
    s_add_u32 s33, s33, s87
    buffer_load_dwordx4 v2, s[4:7], s35 offen offset:0 nt lds
    buffer_load_dwordx4 v3, s[4:7], s35 offen offset:1024 nt lds
    buffer_load_dwordx4 v4, s[4:7], s35 offen offset:2048 nt lds
    buffer_load_dwordx4 v5, s[4:7], s35 offen offset:3072 nt lds
    s_mov_b32 m0, s31
    s_add_u32 s35, s34, 4096
    buffer_load_dwordx4 v6, s[8:11], s34 offen offset:0 nt lds
    buffer_load_dwordx4 v6, s[8:11], s34 offen offset:1024 nt lds
    buffer_load_dwordx4 v6, s[8:11], s34 offen offset:2048 nt lds
    buffer_load_dwordx4 v6, s[8:11], s34 offen offset:3072 nt lds
    s_add_u32 m0, s31, 4096
    s_add_u32 s34, s34, 32768
    buffer_load_dwordx4 v6, s[8:11], s35 offen offset:0 nt lds
    buffer_load_dwordx4 v6, s[8:11], s35 offen offset:1024 nt lds
    buffer_load_dwordx4 v6, s[8:11], s35 offen offset:2048 nt lds
    buffer_load_dwordx4 v6, s[8:11], s35 offen offset:3072 nt lds
    s_branch L_pc0
L_pB0:
    s_mov_b32 m0, s53
    s_add_u32 s35, s39, 0
    buffer_load_dwordx4 v7, s[12:15], s35 offen offset:0  lds
    s_add_u32 s35, s39, 64512
    buffer_load_dwordx4 v7, s[12:15], s35 offen offset:1024  lds
    s_add_u32 s35, s39, 129024
    buffer_load_dwordx4 v7, s[12:15], s35 offen offset:2048  lds
    s_add_u32 s35, s39, 193536
    buffer_load_dwordx4 v7, s[12:15], s35 offen offset:3072  lds
    s_add_u32 m0, s53, 4096
    s_add_u32 s35, s39, 262144
    buffer_load_dwordx4 v7, s[12:15], s35 offen offset:0  lds
    s_add_u32 s35, s39, 326656
    buffer_load_dwordx4 v7, s[12:15], s35 offen offset:1024  lds
    s_add_u32 s35, s39, 391168
    buffer_load_dwordx4 v7, s[12:15], s35 offen offset:2048  lds
    s_add_u32 s35, s39, 455680
    buffer_load_dwordx4 v7, s[12:15], s35 offen offset:3072  lds
    s_add_u32 s39, s39, 524288
L_pc0:
    s_cmp_lg_u32 s93, 0
    s_cbranch_scc1 L_nocpf
    s_getpc_b64 s[96:97]
    s_lshl_b32 s35, s28, 13
    s_add_u32 s96, s96, s35
    s_addc_u32 s97, s97, 0
    v_lshlrev_b32 v40, 7, v31
    s_sub_i32 s35, L_done - L_nocpf, s35
    v_min_i32 v40, s35, v40
    v_mov_b32 v41, s97
    v_add_co_u32 v40, vcc, s96, v40
    s_nop 1
    v_addc_co_u32 v41, vcc, 0, v41, vcc
    s_cmp_lt_i32 s35, 0
    s_cbranch_scc1 L_nocpf
    global_load_dword v30, v[40:41], off
L_nocpf:
    s_mul_i32 s41, s92, 589824
    s_mul_i32 s35, s28, 73728
    s_add_u32 s54, s41, s35
    s_add_u32 s54, s54, 1024
    s_add_u32 s41, s41, s36
    s_mul_i32 s74, s93, 294912
    s_mov_b32 s18, 4718592
    s_mov_b32 s19, 0x20000
    s_mov_b32 s26, 294912
    s_mov_b32 s27, 0x20000
    s_mov_b32 s16, s68
    s_mov_b32 s17, s69
    s_add_u32 s24, s70, s74
    s_addc_u32 s25, s71, 0
    s_lshl_b32 s96, s93, 10
    s_add_u32 s96, s96, 0x2000000
    s_add_u32 s96, s70, s96
    s_addc_u32 s97, s71, 0
    s_mov_b32 s98, 1024
    s_mov_b32 s99, 0x20000
    s_mov_b32 s100, 0
    s_mov_b32 s101, 0
    v_lshlrev_b32 v1, 4, v31
    v_and_b32 v36, 31, v31
    v_lshrrev_b32 v37, 5, v31
    v_and_b32 v39, 15, v36
    v_xor_b32 v39, v39, v37
    v_lshlrev_b32 v39, 4, v39
    v_lshl_add_u32 v10, v36, 8, v39
    v_add_u32 v10, 131072, v10
    v_and_b32 v39, 2, v36
    v_lshl_or_b32 v39, v39, 1, v37
    v_lshlrev_b32 v39, 4, v39
    v_lshl_add_u32 v43, v36, 7, v39
    v_add_u32 v43, s38, v43
    v_and_b32 v38, 0x13, v36
    v_and_b32 v39, 4, v36
    v_lshl_or_b32 v38, v39, 1, v38
    v_and_b32 v39, 8, v36
    v_lshrrev_b32 v39, 1, v39
    v_or_b32 v38, v38, v39
    v_and_b32 v39, 15, v38
    v_xor_b32 v39, v39, v37
    v_lshlrev_b32 v39, 4, v39
    v_lshl_add_u32 v11, v38, 8, v39
    v_bfe_u32 v38, v31, 2, 2
    v_lshl_add_u32 v39, v37, 3, v38
    v_and_b32 v40, 1, v33
    v_lshlrev_b32 v40, 5, v40
    v_and_b32 v41, 1, v31
    v_lshl_or_b32 v40, v41, 4, v40
    v_and_b32 v41, 2, v31
    v_lshl_or_b32 v40, v41, 2, v40
    v_xor_b32 v41, s28, v38
    v_lshl_or_b32 v41, v41, 6, v40
    v_lshl_add_u32 v12, v39, 8, v41
    v_lshrrev_b32 v41, 1, v38
    v_lshl_or_b32 v41, v41, 6, v40
    v_lshl_add_u32 v13, v39, 7, v41
    s_lshl_b32 s74, s92, 7
    s_add_u32 s74, s74, 0x2100000
    s_add_u32 s76, s70, s74
    s_addc_u32 s77, s71, 0
    s_mov_b32 s78, 128
    s_mov_b32 s79, 0x20000
    s_mov_b32 s72, 0
    s_mov_b32 s95, 30
    s_lshr_b32 s75, s94, 12
    s_lshl_b32 s75, s75, 8
    s_lshl_b32 s94, s93, 2
    s_cmp_eq_u32 s28, 0
    s_cselect_b32 s94, s94, 128
    s_xor_b32 s51, s38, 32768
    s_xor_b32 s50, s49, 8192
    s_mov_b32 s37, 0x3e0293ee
    s_mov_b32 s58, 0x41000000
    s_mov_b32 s42, 0x00011ff0
    s_mov_b32 s43, 0x00001fe0
    s_mov_b32 s44, 0x00000ff8
    s_mov_b32 s45, 0x00ff0000
    s_mov_b32 s46, 0x01ff1ff0
    s_mov_b32 s56, 0x01ff1ff8
    s_mov_b32 s55, 0x7e016009
    s_mov_b32 s73, s55
    s_bitset1_b32 s55, s100
    s_bitset1_b32 s55, s101
    s_mov_b32 s48, s53
    s_mov_b32 s47, 0
    s_mov_b32 s29, 0
    s_mov_b32 s30, s31
    v_mov_b32 v15, 0
    v_mov_b32 v16, 0
    v_mov_b32 v31, 0
    v_xor_b32 v42, 32, v43
    v_xor_b32 v41, 64, v43
    v_xor_b32 v40, 96, v43
    s_cmp_eq_u32 s59, 0
    s_cbranch_scc1 L_pB1
    s_waitcnt vmcnt(8)
    v_add_u32 v32, s52, v11
    ds_read_b128 a[64:67], v32
    v_xor_b32 v34, 32, v32
    ds_read_b128 a[68:71], v34
    v_xor_b32 v33, 64, v32
    ds_read_b128 a[72:75], v33
    v_xor_b32 v34, 96, v32
    ds_read_b128 a[76:79], v34
    v_xor_b32 v33, 128, v32
    ds_read_b128 a[80:83], v33
    v_xor_b32 v34, 160, v32
    ds_read_b128 a[84:87], v34
    v_xor_b32 v33, 192, v32
    ds_read_b128 a[88:91], v33
    v_xor_b32 v34, 224, v32
    ds_read_b128 a[92:95], v34
    v_add_u32 v32, s53, v11
    ds_read_b128 a[96:99], v32
    v_xor_b32 v34, 32, v32
    ds_read_b128 a[100:103], v34
    v_xor_b32 v33, 64, v32
    ds_read_b128 a[104:107], v33
    v_xor_b32 v34, 96, v32
    ds_read_b128 a[108:111], v34
    v_xor_b32 v33, 128, v32
    ds_read_b128 a[112:115], v33
    v_xor_b32 v34, 160, v32
    ds_read_b128 a[116:119], v34
    v_xor_b32 v33, 192, v32
    ds_read_b128 a[120:123], v33
    v_xor_b32 v34, 224, v32
    ds_read_b128 a[124:127], v34
    s_waitcnt lgkmcnt(0)
    s_mov_b32 m0, s52
    s_add_u32 s35, s33, s86
    buffer_load_dwordx4 v2, s[4:7], s33 offen offset:0 nt lds
    buffer_load_dwordx4 v3, s[4:7], s33 offen offset:1024 nt lds
    buffer_load_dwordx4 v4, s[4:7], s33 offen offset:2048 nt lds
    buffer_load_dwordx4 v5, s[4:7], s33 offen offset:3072 nt lds
    s_add_u32 m0, s52, 4096
    s_add_u32 s33, s33, s87
    buffer_load_dwordx4 v2, s[4:7], s35 offen offset:0 nt lds
    buffer_load_dwordx4 v3, s[4:7], s35 offen offset:1024 nt lds
    buffer_load_dwordx4 v4, s[4:7], s35 offen offset:2048 nt lds
    buffer_load_dwordx4 v5, s[4:7], s35 offen offset:3072 nt lds
    s_mov_b32 m0, s53
    s_add_u32 s35, s39, 0
    buffer_load_dwordx4 v7, s[12:15], s35 offen offset:0  lds
    s_add_u32 s35, s39, 64512
    buffer_load_dwordx4 v7, s[12:15], s35 offen offset:1024  lds
    s_add_u32 s35, s39, 129024
    buffer_load_dwordx4 v7, s[12:15], s35 offen offset:2048  lds
    s_add_u32 s35, s39, 193536
    buffer_load_dwordx4 v7, s[12:15], s35 offen offset:3072  lds
    s_add_u32 m0, s53, 4096
    s_add_u32 s35, s39, 262144
    buffer_load_dwordx4 v7, s[12:15], s35 offen offset:0  lds
    s_add_u32 s35, s39, 326656
    buffer_load_dwordx4 v7, s[12:15], s35 offen offset:1024  lds
    s_add_u32 s35, s39, 391168
    buffer_load_dwordx4 v7, s[12:15], s35 offen offset:2048  lds
    s_add_u32 s35, s39, 455680
    buffer_load_dwordx4 v7, s[12:15], s35 offen offset:3072  lds
    s_add_u32 s39, s39, 524288
L_pB1:
    s_waitcnt vmcnt(8)
    ds_read_b128 a[224:227], v43
    ds_read_b128 a[228:231], v42
    ds_read_b128 a[232:235], v41
    ds_read_b128 a[236:239], v40
    v_add_u32 v34, s53, v13
    v_xor_b32 v35, 64, v34
    v_add_u32 v36, s38, v13
    v_xor_b32 v37, 64, v36
    s_waitcnt lgkmcnt(0)
    s_mov_b32 m0, s38
    s_add_u32 s35, s39, 0
    buffer_load_dwordx4 v7, s[12:15], s35 offen offset:0  lds
    s_add_u32 s35, s39, 64512
    buffer_load_dwordx4 v7, s[12:15], s35 offen offset:1024  lds
    s_add_u32 s35, s39, 129024
    buffer_load_dwordx4 v7, s[12:15], s35 offen offset:2048  lds
    s_add_u32 s35, s39, 193536
    buffer_load_dwordx4 v7, s[12:15], s35 offen offset:3072  lds
    s_add_u32 m0, s38, 4096
    s_add_u32 s35, s39, 262144
    buffer_load_dwordx4 v7, s[12:15], s35 offen offset:0  lds
    s_add_u32 s35, s39, 326656
    buffer_load_dwordx4 v7, s[12:15], s35 offen offset:1024  lds
    s_add_u32 s35, s39, 391168
    buffer_load_dwordx4 v7, s[12:15], s35 offen offset:2048  lds
    s_add_u32 s35, s39, 455680
    buffer_load_dwordx4 v7, s[12:15], s35 offen offset:3072  lds
    s_add_u32 s39, s39, 524288
    s_barrier
    v_xor_b32 v40, 0, v10
    v_xor_b32 v41, 32, v10
    v_xor_b32 v42, 64, v10
    v_xor_b32 v43, 96, v10
    v_xor_b32 v44, 128, v10
    v_xor_b32 v45, 160, v10
    v_xor_b32 v46, 192, v10
    v_xor_b32 v47, 224, v10
    s_waitcnt vmcnt(8)
    ds_read_b128 v[112:115], v40 offset:0
    ds_read_b64_tr_b16 v[48:49], v34 offset:0
    ds_read_b64_tr_b16 v[50:51], v34 offset:512
    ds_read_b64_tr_b16 v[52:53], v35 offset:0
    ds_read_b64_tr_b16 v[54:55], v35 offset:512
    ds_read_b128 v[116:119], v41 offset:0
    ds_read_b64_tr_b16 v[56:57], v34 offset:2048
    ds_read_b64_tr_b16 v[58:59], v34 offset:2560
    ds_read_b64_tr_b16 v[60:61], v35 offset:2048
    ds_read_b64_tr_b16 v[62:63], v35 offset:2560
    ds_read_b128 v[120:123], v42 offset:0
    ds_read_b64_tr_b16 v[64:65], v34 offset:4096
    ds_read_b64_tr_b16 v[66:67], v34 offset:4608
    ds_read_b64_tr_b16 v[68:69], v35 offset:4096
    ds_read_b64_tr_b16 v[70:71], v35 offset:4608
    ds_read_b128 v[124:127], v43 offset:0
    ds_read_b64_tr_b16 v[72:73], v34 offset:6144
    ds_read_b64_tr_b16 v[74:75], v34 offset:6656
    ds_read_b64_tr_b16 v[76:77], v35 offset:6144
    ds_read_b64_tr_b16 v[78:79], v35 offset:6656
    s_waitcnt lgkmcnt(0)
    v_mfma_f32_32x32x16_bf16 a[192:207], v[48:51], v[112:115], 0
    s_mov_b32 m0, s53
    s_add_u32 s35, s39, 0
    buffer_load_dwordx4 v7, s[12:15], s35 offen offset:0  lds
    s_add_u32 s35, s39, 64512
    buffer_load_dwordx4 v7, s[12:15], s35 offen offset:1024  lds
    v_mfma_f32_32x32x16_bf16 a[208:223], v[52:55], v[112:115], 0
    s_add_u32 s35, s39, 129024
    buffer_load_dwordx4 v7, s[12:15], s35 offen offset:2048  lds
    s_add_u32 s35, s39, 193536
    buffer_load_dwordx4 v7, s[12:15], s35 offen offset:3072  lds
    v_mfma_f32_32x32x16_bf16 a[192:207], v[56:59], v[116:119], a[192:207]
    s_add_u32 m0, s53, 4096
    s_add_u32 s35, s39, 262144
    buffer_load_dwordx4 v7, s[12:15], s35 offen offset:0  lds
    s_add_u32 s35, s39, 326656
    buffer_load_dwordx4 v7, s[12:15], s35 offen offset:1024  lds
    v_mfma_f32_32x32x16_bf16 a[208:223], v[60:63], v[116:119], a[208:223]
    s_add_u32 s35, s39, 391168
    buffer_load_dwordx4 v7, s[12:15], s35 offen offset:2048  lds
    s_add_u32 s35, s39, 455680
    buffer_load_dwordx4 v7, s[12:15], s35 offen offset:3072  lds
    v_mfma_f32_32x32x16_bf16 a[192:207], v[64:67], v[120:123], a[192:207]
    s_add_u32 s39, s39, 524288
    s_waitcnt vmcnt(8)
    ds_read_b128 a[240:243], v44 offset:0
    ds_read_b64_tr_b16 v[80:81], v36 offset:0
    ds_read_b64_tr_b16 v[82:83], v36 offset:512
    ds_read_b64_tr_b16 v[84:85], v37 offset:0
    v_mfma_f32_32x32x16_bf16 a[208:223], v[68:71], v[120:123], a[208:223]
    ds_read_b64_tr_b16 v[86:87], v37 offset:512
    ds_read_b128 a[244:247], v45 offset:0
    ds_read_b64_tr_b16 v[88:89], v36 offset:2048
    ds_read_b64_tr_b16 v[90:91], v36 offset:2560
    ds_read_b64_tr_b16 v[92:93], v37 offset:2048
    v_mfma_f32_32x32x16_bf16 a[192:207], v[72:75], v[124:127], a[192:207]
    ds_read_b64_tr_b16 v[94:95], v37 offset:2560
    ds_read_b128 a[248:251], v46 offset:0
    ds_read_b64_tr_b16 v[96:97], v36 offset:4096
    ds_read_b64_tr_b16 v[98:99], v36 offset:4608
    ds_read_b64_tr_b16 v[100:101], v37 offset:4096
    ds_read_b64_tr_b16 v[102:103], v37 offset:4608
    v_mfma_f32_32x32x16_bf16 a[208:223], v[76:79], v[124:127], a[208:223]
    ds_read_b128 a[252:255], v47 offset:0
    ds_read_b64_tr_b16 v[104:105], v36 offset:6144
    ds_read_b64_tr_b16 v[106:107], v36 offset:6656
    ds_read_b64_tr_b16 v[108:109], v37 offset:6144
    ds_read_b64_tr_b16 v[110:111], v37 offset:6656
    s_waitcnt lgkmcnt(0)
    v_mfma_f32_32x32x16_bf16 a[192:207], v[80:83], a[240:243], a[192:207]
    s_mov_b32 m0, s38
    s_add_u32 s35, s39, 0
    buffer_load_dwordx4 v7, s[12:15], s35 offen offset:0  lds
    s_add_u32 s35, s39, 64512
    buffer_load_dwordx4 v7, s[12:15], s35 offen offset:1024  lds
    v_mfma_f32_32x32x16_bf16 a[208:223], v[84:87], a[240:243], a[208:223]
    s_add_u32 s35, s39, 129024
    buffer_load_dwordx4 v7, s[12:15], s35 offen offset:2048  lds
    s_add_u32 s35, s39, 193536
    buffer_load_dwordx4 v7, s[12:15], s35 offen offset:3072  lds
    v_mfma_f32_32x32x16_bf16 a[192:207], v[88:91], a[244:247], a[192:207]
    s_add_u32 m0, s38, 4096
    s_add_u32 s35, s39, 262144
    buffer_load_dwordx4 v7, s[12:15], s35 offen offset:0  lds
    s_add_u32 s35, s39, 326656
    buffer_load_dwordx4 v7, s[12:15], s35 offen offset:1024  lds
    v_mfma_f32_32x32x16_bf16 a[208:223], v[92:95], a[244:247], a[208:223]
    s_add_u32 s35, s39, 391168
    buffer_load_dwordx4 v7, s[12:15], s35 offen offset:2048  lds
    s_add_u32 s35, s39, 455680
    buffer_load_dwordx4 v7, s[12:15], s35 offen offset:3072  lds
    v_mfma_f32_32x32x16_bf16 a[192:207], v[96:99], a[248:251], a[192:207]
    s_add_u32 s39, s39, 524288
    s_waitcnt vmcnt(8)
    ds_read_b128 v[112:115], v40 offset:8192
    ds_read_b64_tr_b16 v[48:49], v34 offset:0
    ds_read_b64_tr_b16 v[50:51], v34 offset:512
    ds_read_b64_tr_b16 v[52:53], v35 offset:0
    v_mfma_f32_32x32x16_bf16 a[208:223], v[100:103], a[248:251], a[208:223]
    ds_read_b64_tr_b16 v[54:55], v35 offset:512
    ds_read_b128 v[116:119], v41 offset:8192
    ds_read_b64_tr_b16 v[56:57], v34 offset:2048
    ds_read_b64_tr_b16 v[58:59], v34 offset:2560
    ds_read_b64_tr_b16 v[60:61], v35 offset:2048
    v_mfma_f32_32x32x16_bf16 a[192:207], v[104:107], a[252:255], a[192:207]
    ds_read_b64_tr_b16 v[62:63], v35 offset:2560
    ds_read_b128 v[120:123], v42 offset:8192
    ds_read_b64_tr_b16 v[64:65], v34 offset:4096
    ds_read_b64_tr_b16 v[66:67], v34 offset:4608
    ds_read_b64_tr_b16 v[68:69], v35 offset:4096
    ds_read_b64_tr_b16 v[70:71], v35 offset:4608
    v_mfma_f32_32x32x16_bf16 a[208:223], v[108:111], a[252:255], a[208:223]
    ds_read_b128 v[124:127], v43 offset:8192
    ds_read_b64_tr_b16 v[72:73], v34 offset:6144
    ds_read_b64_tr_b16 v[74:75], v34 offset:6656
    ds_read_b64_tr_b16 v[76:77], v35 offset:6144
    ds_read_b64_tr_b16 v[78:79], v35 offset:6656
    s_waitcnt lgkmcnt(0)
    v_mfma_f32_32x32x16_bf16 a[192:207], v[48:51], v[112:115], a[192:207]
    s_mov_b32 m0, s53
    s_add_u32 s35, s39, 0
    buffer_load_dwordx4 v7, s[12:15], s35 offen offset:0  lds
    s_add_u32 s35, s39, 64512
    buffer_load_dwordx4 v7, s[12:15], s35 offen offset:1024  lds
    v_mfma_f32_32x32x16_bf16 a[208:223], v[52:55], v[112:115], a[208:223]
    s_add_u32 s35, s39, 129024
    buffer_load_dwordx4 v7, s[12:15], s35 offen offset:2048  lds
    s_add_u32 s35, s39, 193536
    buffer_load_dwordx4 v7, s[12:15], s35 offen offset:3072  lds
    v_mfma_f32_32x32x16_bf16 a[192:207], v[56:59], v[116:119], a[192:207]
    s_add_u32 m0, s53, 4096
    s_add_u32 s35, s39, 262144
    buffer_load_dwordx4 v7, s[12:15], s35 offen offset:0  lds
    s_add_u32 s35, s39, 326656
    buffer_load_dwordx4 v7, s[12:15], s35 offen offset:1024  lds
    v_mfma_f32_32x32x16_bf16 a[208:223], v[60:63], v[116:119], a[208:223]
    s_add_u32 s35, s39, 391168
    buffer_load_dwordx4 v7, s[12:15], s35 offen offset:2048  lds
    s_add_u32 s35, s39, 455680
    buffer_load_dwordx4 v7, s[12:15], s35 offen offset:3072  lds
    v_mfma_f32_32x32x16_bf16 a[192:207], v[64:67], v[120:123], a[192:207]
    s_add_u32 s39, s39, 524288
    s_waitcnt vmcnt(8)
    ds_read_b128 a[240:243], v44 offset:8192
    ds_read_b64_tr_b16 v[80:81], v36 offset:0
    ds_read_b64_tr_b16 v[82:83], v36 offset:512
    ds_read_b64_tr_b16 v[84:85], v37 offset:0
    v_mfma_f32_32x32x16_bf16 a[208:223], v[68:71], v[120:123], a[208:223]
    ds_read_b64_tr_b16 v[86:87], v37 offset:512
    ds_read_b128 a[244:247], v45 offset:8192
    ds_read_b64_tr_b16 v[88:89], v36 offset:2048
    ds_read_b64_tr_b16 v[90:91], v36 offset:2560
    ds_read_b64_tr_b16 v[92:93], v37 offset:2048
    v_mfma_f32_32x32x16_bf16 a[192:207], v[72:75], v[124:127], a[192:207]
    ds_read_b64_tr_b16 v[94:95], v37 offset:2560
    ds_read_b128 a[248:251], v46 offset:8192
    ds_read_b64_tr_b16 v[96:97], v36 offset:4096
    ds_read_b64_tr_b16 v[98:99], v36 offset:4608
    ds_read_b64_tr_b16 v[100:101], v37 offset:4096
    ds_read_b64_tr_b16 v[102:103], v37 offset:4608
    v_mfma_f32_32x32x16_bf16 a[208:223], v[76:79], v[124:127], a[208:223]
    ds_read_b128 a[252:255], v47 offset:8192
    ds_read_b64_tr_b16 v[104:105], v36 offset:6144
    ds_read_b64_tr_b16 v[106:107], v36 offset:6656
    ds_read_b64_tr_b16 v[108:109], v37 offset:6144
    ds_read_b64_tr_b16 v[110:111], v37 offset:6656
    s_waitcnt lgkmcnt(0)
    v_mfma_f32_32x32x16_bf16 a[192:207], v[80:83], a[240:243], a[192:207]
    s_mov_b32 m0, s38
    s_add_u32 s35, s39, 0
    buffer_load_dwordx4 v7, s[12:15], s35 offen offset:0  lds
    s_add_u32 s35, s39, 64512
    buffer_load_dwordx4 v7, s[12:15], s35 offen offset:1024  lds
    v_mfma_f32_32x32x16_bf16 a[208:223], v[84:87], a[240:243], a[208:223]
    s_add_u32 s35, s39, 129024
    buffer_load_dwordx4 v7, s[12:15], s35 offen offset:2048  lds
    s_add_u32 s35, s39, 193536
    buffer_load_dwordx4 v7, s[12:15], s35 offen offset:3072  lds
    v_mfma_f32_32x32x16_bf16 a[192:207], v[88:91], a[244:247], a[192:207]
    s_add_u32 m0, s38, 4096
    s_add_u32 s35, s39, 262144
    buffer_load_dwordx4 v7, s[12:15], s35 offen offset:0  lds
    s_add_u32 s35, s39, 326656
    buffer_load_dwordx4 v7, s[12:15], s35 offen offset:1024  lds
    v_mfma_f32_32x32x16_bf16 a[208:223], v[92:95], a[244:247], a[208:223]
    s_add_u32 s35, s39, 391168
    buffer_load_dwordx4 v7, s[12:15], s35 offen offset:2048  lds
    s_add_u32 s35, s39, 455680
    buffer_load_dwordx4 v7, s[12:15], s35 offen offset:3072  lds
    v_mfma_f32_32x32x16_bf16 a[192:207], v[96:99], a[248:251], a[192:207]
    s_add_u32 s39, s39, 524288
    s_waitcnt vmcnt(8)
    ds_read_b128 v[112:115], v40 offset:16384
    ds_read_b64_tr_b16 v[48:49], v34 offset:0
    ds_read_b64_tr_b16 v[50:51], v34 offset:512
    ds_read_b64_tr_b16 v[52:53], v35 offset:0
    v_mfma_f32_32x32x16_bf16 a[208:223], v[100:103], a[248:251], a[208:223]
    ds_read_b64_tr_b16 v[54:55], v35 offset:512
    ds_read_b128 v[116:119], v41 offset:16384
    ds_read_b64_tr_b16 v[56:57], v34 offset:2048
    ds_read_b64_tr_b16 v[58:59], v34 offset:2560
    ds_read_b64_tr_b16 v[60:61], v35 offset:2048
    v_mfma_f32_32x32x16_bf16 a[192:207], v[104:107], a[252:255], a[192:207]
    ds_read_b64_tr_b16 v[62:63], v35 offset:2560
    ds_read_b128 v[120:123], v42 offset:16384
    ds_read_b64_tr_b16 v[64:65], v34 offset:4096
    ds_read_b64_tr_b16 v[66:67], v34 offset:4608
    ds_read_b64_tr_b16 v[68:69], v35 offset:4096
    ds_read_b64_tr_b16 v[70:71], v35 offset:4608
    v_mfma_f32_32x32x16_bf16 a[208:223], v[108:111], a[252:255], a[208:223]
    ds_read_b128 v[124:127], v43 offset:16384
    ds_read_b64_tr_b16 v[72:73], v34 offset:6144
    ds_read_b64_tr_b16 v[74:75], v34 offset:6656
    ds_read_b64_tr_b16 v[76:77], v35 offset:6144
    ds_read_b64_tr_b16 v[78:79], v35 offset:6656
    s_waitcnt lgkmcnt(0)
    v_mfma_f32_32x32x16_bf16 a[192:207], v[48:51], v[112:115], a[192:207]
    s_mov_b32 m0, s53
    s_add_u32 s35, s39, 0
    buffer_load_dwordx4 v7, s[12:15], s35 offen offset:0  lds
    s_add_u32 s35, s39, 64512
    buffer_load_dwordx4 v7, s[12:15], s35 offen offset:1024  lds
    v_mfma_f32_32x32x16_bf16 a[208:223], v[52:55], v[112:115], a[208:223]
    s_add_u32 s35, s39, 129024
    buffer_load_dwordx4 v7, s[12:15], s35 offen offset:2048  lds
    s_add_u32 s35, s39, 193536
    buffer_load_dwordx4 v7, s[12:15], s35 offen offset:3072  lds
    v_mfma_f32_32x32x16_bf16 a[192:207], v[56:59], v[116:119], a[192:207]
    s_add_u32 m0, s53, 4096
    s_add_u32 s35, s39, 262144
    buffer_load_dwordx4 v7, s[12:15], s35 offen offset:0  lds
    s_add_u32 s35, s39, 326656
    buffer_load_dwordx4 v7, s[12:15], s35 offen offset:1024  lds
    v_mfma_f32_32x32x16_bf16 a[208:223], v[60:63], v[116:119], a[208:223]
    s_add_u32 s35, s39, 391168
    buffer_load_dwordx4 v7, s[12:15], s35 offen offset:2048  lds
    s_add_u32 s35, s39, 455680
    buffer_load_dwordx4 v7, s[12:15], s35 offen offset:3072  lds
    v_mfma_f32_32x32x16_bf16 a[192:207], v[64:67], v[120:123], a[192:207]
    s_add_u32 s39, s39, 524288
    s_waitcnt vmcnt(8)
    ds_read_b128 a[240:243], v44 offset:16384
    ds_read_b64_tr_b16 v[80:81], v36 offset:0
    ds_read_b64_tr_b16 v[82:83], v36 offset:512
    ds_read_b64_tr_b16 v[84:85], v37 offset:0
    v_mfma_f32_32x32x16_bf16 a[208:223], v[68:71], v[120:123], a[208:223]
    ds_read_b64_tr_b16 v[86:87], v37 offset:512
    ds_read_b128 a[244:247], v45 offset:16384
    ds_read_b64_tr_b16 v[88:89], v36 offset:2048
    ds_read_b64_tr_b16 v[90:91], v36 offset:2560
    ds_read_b64_tr_b16 v[92:93], v37 offset:2048
    v_mfma_f32_32x32x16_bf16 a[192:207], v[72:75], v[124:127], a[192:207]
    ds_read_b64_tr_b16 v[94:95], v37 offset:2560
    ds_read_b128 a[248:251], v46 offset:16384
    ds_read_b64_tr_b16 v[96:97], v36 offset:4096
    ds_read_b64_tr_b16 v[98:99], v36 offset:4608
    ds_read_b64_tr_b16 v[100:101], v37 offset:4096
    ds_read_b64_tr_b16 v[102:103], v37 offset:4608
    v_mfma_f32_32x32x16_bf16 a[208:223], v[76:79], v[124:127], a[208:223]
    ds_read_b128 a[252:255], v47 offset:16384
    ds_read_b64_tr_b16 v[104:105], v36 offset:6144
    ds_read_b64_tr_b16 v[106:107], v36 offset:6656
    ds_read_b64_tr_b16 v[108:109], v37 offset:6144
    ds_read_b64_tr_b16 v[110:111], v37 offset:6656
    s_waitcnt lgkmcnt(0)
    v_mfma_f32_32x32x16_bf16 a[192:207], v[80:83], a[240:243], a[192:207]
    s_mov_b32 m0, s38
    s_add_u32 s35, s39, 0
    buffer_load_dwordx4 v7, s[12:15], s35 offen offset:0  lds
    s_add_u32 s35, s39, 64512
    buffer_load_dwordx4 v7, s[12:15], s35 offen offset:1024  lds
    v_mfma_f32_32x32x16_bf16 a[208:223], v[84:87], a[240:243], a[208:223]
    s_add_u32 s35, s39, 129024
    buffer_load_dwordx4 v7, s[12:15], s35 offen offset:2048  lds
    s_add_u32 s35, s39, 193536
    buffer_load_dwordx4 v7, s[12:15], s35 offen offset:3072  lds
    v_mfma_f32_32x32x16_bf16 a[192:207], v[88:91], a[244:247], a[192:207]
    s_add_u32 m0, s38, 4096
    s_add_u32 s35, s39, 262144
    buffer_load_dwordx4 v7, s[12:15], s35 offen offset:0  lds
    s_add_u32 s35, s39, 326656
    buffer_load_dwordx4 v7, s[12:15], s35 offen offset:1024  lds
    v_mfma_f32_32x32x16_bf16 a[208:223], v[92:95], a[244:247], a[208:223]
    s_add_u32 s35, s39, 391168
    buffer_load_dwordx4 v7, s[12:15], s35 offen offset:2048  lds
    s_add_u32 s35, s39, 455680
    buffer_load_dwordx4 v7, s[12:15], s35 offen offset:3072  lds
    v_mfma_f32_32x32x16_bf16 a[192:207], v[96:99], a[248:251], a[192:207]
    s_add_u32 s39, s39, 524288
    s_waitcnt vmcnt(8)
    ds_read_b128 v[112:115], v40 offset:24576
    ds_read_b64_tr_b16 v[48:49], v34 offset:0
    ds_read_b64_tr_b16 v[50:51], v34 offset:512
    ds_read_b64_tr_b16 v[52:53], v35 offset:0
    v_mfma_f32_32x32x16_bf16 a[208:223], v[100:103], a[248:251], a[208:223]
    ds_read_b64_tr_b16 v[54:55], v35 offset:512
    ds_read_b128 v[116:119], v41 offset:24576
    ds_read_b64_tr_b16 v[56:57], v34 offset:2048
    ds_read_b64_tr_b16 v[58:59], v34 offset:2560
    ds_read_b64_tr_b16 v[60:61], v35 offset:2048
    v_mfma_f32_32x32x16_bf16 a[192:207], v[104:107], a[252:255], a[192:207]
    ds_read_b64_tr_b16 v[62:63], v35 offset:2560
    ds_read_b128 v[120:123], v42 offset:24576
    ds_read_b64_tr_b16 v[64:65], v34 offset:4096
    ds_read_b64_tr_b16 v[66:67], v34 offset:4608
    ds_read_b64_tr_b16 v[68:69], v35 offset:4096
    ds_read_b64_tr_b16 v[70:71], v35 offset:4608
    v_mfma_f32_32x32x16_bf16 a[208:223], v[108:111], a[252:255], a[208:223]
    ds_read_b128 v[124:127], v43 offset:24576
    ds_read_b64_tr_b16 v[72:73], v34 offset:6144
    ds_read_b64_tr_b16 v[74:75], v34 offset:6656
    ds_read_b64_tr_b16 v[76:77], v35 offset:6144
    ds_read_b64_tr_b16 v[78:79], v35 offset:6656
    s_waitcnt lgkmcnt(0)
    v_mfma_f32_32x32x16_bf16 a[192:207], v[48:51], v[112:115], a[192:207]
    s_mov_b32 m0, s53
    s_add_u32 s35, s39, 0
    buffer_load_dwordx4 v7, s[12:15], s35 offen offset:0  lds
    s_add_u32 s35, s39, 64512
    buffer_load_dwordx4 v7, s[12:15], s35 offen offset:1024  lds
    v_mfma_f32_32x32x16_bf16 a[208:223], v[52:55], v[112:115], a[208:223]
    s_add_u32 s35, s39, 129024
    buffer_load_dwordx4 v7, s[12:15], s35 offen offset:2048  lds
    s_add_u32 s35, s39, 193536
    buffer_load_dwordx4 v7, s[12:15], s35 offen offset:3072  lds
    v_mfma_f32_32x32x16_bf16 a[192:207], v[56:59], v[116:119], a[192:207]
    s_add_u32 m0, s53, 4096
    s_add_u32 s35, s39, 262144
    buffer_load_dwordx4 v7, s[12:15], s35 offen offset:0  lds
    s_add_u32 s35, s39, 326656
    buffer_load_dwordx4 v7, s[12:15], s35 offen offset:1024  lds
    v_mfma_f32_32x32x16_bf16 a[208:223], v[60:63], v[116:119], a[208:223]
    s_add_u32 s35, s39, 391168
    buffer_load_dwordx4 v7, s[12:15], s35 offen offset:2048  lds
    s_add_u32 s35, s39, 455680
    buffer_load_dwordx4 v7, s[12:15], s35 offen offset:3072  lds
    v_mfma_f32_32x32x16_bf16 a[192:207], v[64:67], v[120:123], a[192:207]
    s_add_u32 s39, s39, 524288
    s_waitcnt vmcnt(8)
    ds_read_b128 a[240:243], v44 offset:24576
    ds_read_b64_tr_b16 v[80:81], v36 offset:0
    ds_read_b64_tr_b16 v[82:83], v36 offset:512
    ds_read_b64_tr_b16 v[84:85], v37 offset:0
    v_mfma_f32_32x32x16_bf16 a[208:223], v[68:71], v[120:123], a[208:223]
    ds_read_b64_tr_b16 v[86:87], v37 offset:512
    ds_read_b128 a[244:247], v45 offset:24576
    ds_read_b64_tr_b16 v[88:89], v36 offset:2048
    ds_read_b64_tr_b16 v[90:91], v36 offset:2560
    ds_read_b64_tr_b16 v[92:93], v37 offset:2048
    v_mfma_f32_32x32x16_bf16 a[192:207], v[72:75], v[124:127], a[192:207]
    ds_read_b64_tr_b16 v[94:95], v37 offset:2560
    ds_read_b128 a[248:251], v46 offset:24576
    ds_read_b64_tr_b16 v[96:97], v36 offset:4096
    ds_read_b64_tr_b16 v[98:99], v36 offset:4608
    ds_read_b64_tr_b16 v[100:101], v37 offset:4096
    ds_read_b64_tr_b16 v[102:103], v37 offset:4608
    v_mfma_f32_32x32x16_bf16 a[208:223], v[76:79], v[124:127], a[208:223]
    ds_read_b128 a[252:255], v47 offset:24576
    ds_read_b64_tr_b16 v[104:105], v36 offset:6144
    ds_read_b64_tr_b16 v[106:107], v36 offset:6656
    ds_read_b64_tr_b16 v[108:109], v37 offset:6144
    ds_read_b64_tr_b16 v[110:111], v37 offset:6656
    s_cmp_lg_u32 s59, 0
    s_cbranch_scc1 L_pA1
    s_mov_b32 m0, s52
    s_add_u32 s35, s33, s86
    buffer_load_dwordx4 v2, s[4:7], s33 offen offset:0 nt lds
    buffer_load_dwordx4 v3, s[4:7], s33 offen offset:1024 nt lds
    buffer_load_dwordx4 v4, s[4:7], s33 offen offset:2048 nt lds
    buffer_load_dwordx4 v5, s[4:7], s33 offen offset:3072 nt lds
    s_add_u32 m0, s52, 4096
    s_add_u32 s33, s33, s87
    buffer_load_dwordx4 v2, s[4:7], s35 offen offset:0 nt lds
    buffer_load_dwordx4 v3, s[4:7], s35 offen offset:1024 nt lds
    buffer_load_dwordx4 v4, s[4:7], s35 offen offset:2048 nt lds
    buffer_load_dwordx4 v5, s[4:7], s35 offen offset:3072 nt lds
    s_mov_b32 m0, s31
    s_add_u32 s35, s34, 4096
    buffer_load_dwordx4 v6, s[8:11], s34 offen offset:0 nt lds
    buffer_load_dwordx4 v6, s[8:11], s34 offen offset:1024 nt lds
    buffer_load_dwordx4 v6, s[8:11], s34 offen offset:2048 nt lds
    buffer_load_dwordx4 v6, s[8:11], s34 offen offset:3072 nt lds
    s_add_u32 m0, s31, 4096
    s_add_u32 s34, s34, 32768
    buffer_load_dwordx4 v6, s[8:11], s35 offen offset:0 nt lds
    buffer_load_dwordx4 v6, s[8:11], s35 offen offset:1024 nt lds
    buffer_load_dwordx4 v6, s[8:11], s35 offen offset:2048 nt lds
    buffer_load_dwordx4 v6, s[8:11], s35 offen offset:3072 nt lds
L_pA1:
    s_waitcnt lgkmcnt(0)
    v_mfma_f32_32x32x16_bf16 a[192:207], v[80:83], a[240:243], a[192:207]
    s_cmp_eq_u32 s59, 0
    s_cbranch_scc1 L_pa_1
    s_waitcnt vmcnt(0)
L_pa_1:
    s_waitcnt vmcnt(16)
    ds_read_b64_tr_b16 v[48:49], v34 offset:0
    v_mfma_f32_32x32x16_bf16 a[208:223], v[84:87], a[240:243], a[208:223]
    ds_read_b64_tr_b16 v[50:51], v34 offset:512
    ds_read_b64_tr_b16 v[52:53], v35 offset:0
    v_mfma_f32_32x32x16_bf16 a[192:207], v[88:91], a[244:247], a[192:207]
    ds_read_b64_tr_b16 v[54:55], v35 offset:512
    ds_read_b64_tr_b16 v[56:57], v34 offset:2048
    v_mfma_f32_32x32x16_bf16 a[208:223], v[92:95], a[244:247], a[208:223]
    ds_read_b64_tr_b16 v[58:59], v34 offset:2560
    ds_read_b64_tr_b16 v[60:61], v35 offset:2048
    v_mfma_f32_32x32x16_bf16 a[192:207], v[96:99], a[248:251], a[192:207]
    ds_read_b64_tr_b16 v[62:63], v35 offset:2560
    ds_read_b64_tr_b16 v[64:65], v34 offset:4096
    v_mfma_f32_32x32x16_bf16 a[208:223], v[100:103], a[248:251], a[208:223]
    ds_read_b64_tr_b16 v[66:67], v34 offset:4608
    ds_read_b64_tr_b16 v[68:69], v35 offset:4096
    ds_read_b64_tr_b16 v[70:71], v35 offset:4608
    v_mfma_f32_32x32x16_bf16 a[192:207], v[104:107], a[252:255], a[192:207]
    ds_read_b64_tr_b16 v[72:73], v34 offset:6144
    ds_read_b64_tr_b16 v[74:75], v34 offset:6656
    v_mfma_f32_32x32x16_bf16 a[208:223], v[108:111], a[252:255], a[208:223]
    ds_read_b64_tr_b16 v[76:77], v35 offset:6144
    ds_read_b64_tr_b16 v[78:79], v35 offset:6656
    s_waitcnt lgkmcnt(0)
    v_mfma_f32_32x32x16_bf16 a[192:207], v[48:51], a[224:227], a[192:207]
    v_mfma_f32_32x32x16_bf16 a[208:223], v[52:55], a[224:227], a[208:223]
    v_mfma_f32_32x32x16_bf16 a[192:207], v[56:59], a[228:231], a[192:207]
    v_mfma_f32_32x32x16_bf16 a[208:223], v[60:63], a[228:231], a[208:223]
    v_mfma_f32_32x32x16_bf16 a[192:207], v[64:67], a[232:235], a[192:207]
    v_mfma_f32_32x32x16_bf16 a[208:223], v[68:71], a[232:235], a[208:223]
    v_mfma_f32_32x32x16_bf16 a[192:207], v[72:75], a[236:239], a[192:207]
    v_mfma_f32_32x32x16_bf16 a[208:223], v[76:79], a[236:239], a[208:223]
    s_cmp_lg_u32 s59, 0
    s_cbranch_scc1 L_pA2
    s_mov_b32 m0, s53
    s_add_u32 s35, s33, s86
    buffer_load_dwordx4 v2, s[4:7], s33 offen offset:0 nt lds
    buffer_load_dwordx4 v3, s[4:7], s33 offen offset:1024 nt lds
    buffer_load_dwordx4 v4, s[4:7], s33 offen offset:2048 nt lds
    buffer_load_dwordx4 v5, s[4:7], s33 offen offset:3072 nt lds
    s_add_u32 m0, s53, 4096
    s_add_u32 s33, s33, s87
    buffer_load_dwordx4 v2, s[4:7], s35 offen offset:0 nt lds
    buffer_load_dwordx4 v3, s[4:7], s35 offen offset:1024 nt lds
    buffer_load_dwordx4 v4, s[4:7], s35 offen offset:2048 nt lds
    buffer_load_dwordx4 v5, s[4:7], s35 offen offset:3072 nt lds
    s_branch L_pc2
L_pA2:
    s_mov_b32 m0, s53
    s_add_u32 s35, s34, 4096
    buffer_load_dwordx4 v6, s[8:11], s34 offen offset:0 nt lds
    buffer_load_dwordx4 v6, s[8:11], s34 offen offset:1024 nt lds
    buffer_load_dwordx4 v6, s[8:11], s34 offen offset:2048 nt lds
    buffer_load_dwordx4 v6, s[8:11], s34 offen offset:3072 nt lds
    s_add_u32 m0, s53, 4096
    s_add_u32 s34, s34, 32768
    buffer_load_dwordx4 v6, s[8:11], s35 offen offset:0 nt lds
    buffer_load_dwordx4 v6, s[8:11], s35 offen offset:1024 nt lds
    buffer_load_dwordx4 v6, s[8:11], s35 offen offset:2048 nt lds
    buffer_load_dwordx4 v6, s[8:11], s35 offen offset:3072 nt lds
    s_mov_b32 s74, s34
    s_mov_b32 s34, 0x100000
    s_mov_b32 s48, 163840
L_pc2:
    s_sub_u32 s39, s39, 523776
    v_add_u32 v32, s38, v1
    v_add_u32 v33, 24576, v1
    v_add_u32 v34, 90112, v1
    s_nop 7
    v_accvgpr_read_b32 v80, a192
    v_accvgpr_read_b32 v81, a193
    v_accvgpr_read_b32 v82, a194
    v_accvgpr_read_b32 v83, a195
    v_accvgpr_read_b32 v84, a196
    v_accvgpr_read_b32 v85, a197
    v_accvgpr_read_b32 v86, a198
    v_accvgpr_read_b32 v87, a199
    v_accvgpr_read_b32 v88, a200
    v_accvgpr_read_b32 v89, a201
    v_accvgpr_read_b32 v90, a202
    v_accvgpr_read_b32 v91, a203
    v_accvgpr_read_b32 v92, a204
    v_accvgpr_read_b32 v93, a205
    v_accvgpr_read_b32 v94, a206
    v_accvgpr_read_b32 v95, a207
    v_accvgpr_read_b32 v96, a208
    v_accvgpr_read_b32 v97, a209
    v_accvgpr_read_b32 v98, a210
    v_accvgpr_read_b32 v99, a211
    v_accvgpr_read_b32 v100, a212
    v_accvgpr_read_b32 v101, a213
    v_accvgpr_read_b32 v102, a214
    v_accvgpr_read_b32 v103, a215
    v_accvgpr_read_b32 v104, a216
    v_accvgpr_read_b32 v105, a217
    v_accvgpr_read_b32 v106, a218
    v_accvgpr_read_b32 v107, a219
    v_accvgpr_read_b32 v108, a220
    v_accvgpr_read_b32 v109, a221
    v_accvgpr_read_b32 v110, a222
    v_accvgpr_read_b32 v111, a223
    v_cvt_pk_bf16_f32 v80, v80, v81
    v_cvt_pk_bf16_f32 v81, v82, v83
    v_cvt_pk_bf16_f32 v82, v84, v85
    v_cvt_pk_bf16_f32 v83, v86, v87
    v_cvt_pk_bf16_f32 v84, v88, v89
    v_cvt_pk_bf16_f32 v85, v90, v91
    v_cvt_pk_bf16_f32 v86, v92, v93
    v_cvt_pk_bf16_f32 v87, v94, v95
    v_cvt_pk_bf16_f32 v88, v96, v97
    v_cvt_pk_bf16_f32 v89, v98, v99
    v_cvt_pk_bf16_f32 v90, v100, v101
    v_cvt_pk_bf16_f32 v91, v102, v103
    v_cvt_pk_bf16_f32 v92, v104, v105
    v_cvt_pk_bf16_f32 v93, v106, v107
    v_cvt_pk_bf16_f32 v94, v108, v109
    v_cvt_pk_bf16_f32 v95, v110, v111
    ds_write_b128 v32, v[80:83] offset:0
    ds_write_b128 v32, v[84:87] offset:1024
    ds_write_b128 v32, v[88:91] offset:2048
    ds_write_b128 v32, v[92:95] offset:3072
    v_accvgpr_write_b32 a192, 0
    v_accvgpr_write_b32 a193, 0
    v_accvgpr_write_b32 a194, 0
    v_accvgpr_write_b32 a195, 0
    v_accvgpr_write_b32 a196, 0
    v_accvgpr_write_b32 a197, 0
    v_accvgpr_write_b32 a198, 0
    v_accvgpr_write_b32 a199, 0
    v_accvgpr_write_b32 a200, 0
    v_accvgpr_write_b32 a201, 0
    v_accvgpr_write_b32 a202, 0
    v_accvgpr_write_b32 a203, 0
    v_accvgpr_write_b32 a204, 0
    v_accvgpr_write_b32 a205, 0
    v_accvgpr_write_b32 a206, 0
    v_accvgpr_write_b32 a207, 0
    v_accvgpr_write_b32 a208, 0
    v_accvgpr_write_b32 a209, 0
    v_accvgpr_write_b32 a210, 0
    v_accvgpr_write_b32 a211, 0
    v_accvgpr_write_b32 a212, 0
    v_accvgpr_write_b32 a213, 0
    v_accvgpr_write_b32 a214, 0
    v_accvgpr_write_b32 a215, 0
    v_accvgpr_write_b32 a216, 0
    v_accvgpr_write_b32 a217, 0
    v_accvgpr_write_b32 a218, 0
    v_accvgpr_write_b32 a219, 0
    v_accvgpr_write_b32 a220, 0
    v_accvgpr_write_b32 a221, 0
    v_accvgpr_write_b32 a222, 0
    v_accvgpr_write_b32 a223, 0
    s_waitcnt lgkmcnt(0)
    s_barrier
    ds_read_b128 a[0:3], v33 offset:0
    ds_read_b128 a[4:7], v33 offset:1024
    ds_read_b128 a[8:11], v33 offset:2048
    ds_read_b128 a[12:15], v33 offset:3072
    ds_read_b128 a[16:19], v33 offset:32768
    ds_read_b128 a[20:23], v33 offset:33792
    ds_read_b128 a[24:27], v33 offset:34816
    ds_read_b128 a[28:31], v33 offset:35840
    ds_read_b128 a[32:35], v34 offset:0
    ds_read_b128 a[36:39], v34 offset:1024
    ds_read_b128 a[40:43], v34 offset:2048
    ds_read_b128 a[44:47], v34 offset:3072
    ds_read_b128 a[48:51], v34 offset:32768
    ds_read_b128 a[52:55], v34 offset:33792
    ds_read_b128 a[56:59], v34 offset:34816
    ds_read_b128 a[60:63], v34 offset:35840
    s_cmp_lg_u32 s59, 0
    s_cbranch_scc1 L_pA3
    s_waitcnt vmcnt(8)
    v_add_u32 v32, s52, v11
    ds_read_b128 a[64:67], v32
    v_xor_b32 v34, 32, v32
    ds_read_b128 a[68:71], v34
    v_xor_b32 v33, 64, v32
    ds_read_b128 a[72:75], v33
    v_xor_b32 v34, 96, v32
    ds_read_b128 a[76:79], v34
    v_xor_b32 v33, 128, v32
    ds_read_b128 a[80:83], v33
    v_xor_b32 v34, 160, v32
    ds_read_b128 a[84:87], v34
    v_xor_b32 v33, 192, v32
    ds_read_b128 a[88:91], v33
    v_xor_b32 v34, 224, v32
    ds_read_b128 a[92:95], v34
    s_waitcnt lgkmcnt(0)
    s_mov_b32 m0, s52
    s_add_u32 s35, s33, s86
    buffer_load_dwordx4 v2, s[4:7], s33 offen offset:0 nt lds
    buffer_load_dwordx4 v3, s[4:7], s33 offen offset:1024 nt lds
    buffer_load_dwordx4 v4, s[4:7], s33 offen offset:2048 nt lds
    buffer_load_dwordx4 v5, s[4:7], s33 offen offset:3072 nt lds
    s_add_u32 m0, s52, 4096
    s_add_u32 s33, s33, s87
    buffer_load_dwordx4 v2, s[4:7], s35 offen offset:0 nt lds
    buffer_load_dwordx4 v3, s[4:7], s35 offen offset:1024 nt lds
    buffer_load_dwordx4 v4, s[4:7], s35 offen offset:2048 nt lds
    buffer_load_dwordx4 v5, s[4:7], s35 offen offset:3072 nt lds
L_pA3:
    s_waitcnt lgkmcnt(0)
    v_mfma_f32_32x32x16_bf16 v[48:63], a[64:67], a[0:3], 0
    v_mfma_f32_32x32x16_bf16 v[48:63], a[68:71], a[4:7], v[48:63]
    v_mfma_f32_32x32x16_bf16 v[48:63], a[72:75], a[8:11], v[48:63]
    v_mfma_f32_32x32x16_bf16 v[48:63], a[76:79], a[12:15], v[48:63]
    v_mfma_f32_32x32x16_bf16 v[48:63], a[80:83], a[16:19], v[48:63]
    v_mfma_f32_32x32x16_bf16 v[48:63], a[84:87], a[20:23], v[48:63]
    v_mfma_f32_32x32x16_bf16 v[48:63], a[88:91], a[24:27], v[48:63]
    v_mfma_f32_32x32x16_bf16 v[48:63], a[92:95], a[28:31], v[48:63]
    v_mfma_f32_32x32x16_bf16 v[64:79], a[64:67], a[32:35], 0
    v_mfma_f32_32x32x16_bf16 v[64:79], a[68:71], a[36:39], v[64:79]
    v_mfma_f32_32x32x16_bf16 v[64:79], a[72:75], a[40:43], v[64:79]
    v_mfma_f32_32x32x16_bf16 v[64:79], a[76:79], a[44:47], v[64:79]
    v_mfma_f32_32x32x16_bf16 v[64:79], a[80:83], a[48:51], v[64:79]
    s_nop 7
    v_fma_f32 v80, v48, s37, -v15
    v_fma_f32 v81, v49, s37, -v15
    v_fma_f32 v82, v50, s37, -v15
    v_mfma_f32_32x32x16_bf16 v[64:79], a[84:87], a[52:55], v[64:79]
    v_fma_f32 v83, v51, s37, -v15
    v_fma_f32 v84, v52, s37, -v15
    v_fma_f32 v85, v53, s37, -v15
    v_fma_f32 v86, v54, s37, -v15
    v_fma_f32 v87, v55, s37, -v15
    v_mfma_f32_32x32x16_bf16 v[64:79], a[88:91], a[56:59], v[64:79]
    v_fma_f32 v88, v56, s37, -v15
    v_fma_f32 v89, v57, s37, -v15
    v_fma_f32 v90, v58, s37, -v15
    v_fma_f32 v91, v59, s37, -v15
    v_mfma_f32_32x32x16_bf16 v[64:79], a[92:95], a[60:63], v[64:79]
    v_fma_f32 v92, v60, s37, -v15
    v_fma_f32 v93, v61, s37, -v15
    v_fma_f32 v94, v62, s37, -v15
    v_fma_f32 v95, v63, s37, -v15
    s_cmp_lg_u32 s59, 0
    s_cbranch_scc1 L_pA4
    s_waitcnt vmcnt(8)
    v_add_u32 v32, s53, v11
    ds_read_b128 a[64:67], v32
    v_xor_b32 v34, 32, v32
    ds_read_b128 a[68:71], v34
    v_xor_b32 v33, 64, v32
    ds_read_b128 a[72:75], v33
    v_xor_b32 v34, 96, v32
    ds_read_b128 a[76:79], v34
    v_xor_b32 v33, 128, v32
    ds_read_b128 a[80:83], v33
    v_xor_b32 v34, 160, v32
    ds_read_b128 a[84:87], v34
    v_xor_b32 v33, 192, v32
    ds_read_b128 a[88:91], v33
    v_xor_b32 v34, 224, v32
    ds_read_b128 a[92:95], v34
    s_waitcnt lgkmcnt(0)
    s_mov_b32 m0, s53
    s_add_u32 s35, s34, 4096
    buffer_load_dwordx4 v6, s[8:11], s34 offen offset:0 nt lds
    buffer_load_dwordx4 v6, s[8:11], s34 offen offset:1024 nt lds
    buffer_load_dwordx4 v6, s[8:11], s34 offen offset:2048 nt lds
    buffer_load_dwordx4 v6, s[8:11], s34 offen offset:3072 nt lds
    s_add_u32 m0, s53, 4096
    s_add_u32 s34, s34, 32768
    buffer_load_dwordx4 v6, s[8:11], s35 offen offset:0 nt lds
    buffer_load_dwordx4 v6, s[8:11], s35 offen offset:1024 nt lds
    buffer_load_dwordx4 v6, s[8:11], s35 offen offset:2048 nt lds
    buffer_load_dwordx4 v6, s[8:11], s35 offen offset:3072 nt lds
    s_mov_b32 s74, s34
    s_mov_b32 s34, 0x100000
    s_mov_b32 s48, 163840
    s_branch L_pc4
L_pA4:
    v_accvgpr_mov_b32 a64, a96
    v_accvgpr_mov_b32 a65, a97
    v_accvgpr_mov_b32 a66, a98
    v_accvgpr_mov_b32 a67, a99
    v_accvgpr_mov_b32 a68, a100
    v_accvgpr_mov_b32 a69, a101
    v_accvgpr_mov_b32 a70, a102
    v_accvgpr_mov_b32 a71, a103
    v_accvgpr_mov_b32 a72, a104
    v_accvgpr_mov_b32 a73, a105
    v_accvgpr_mov_b32 a74, a106
    v_accvgpr_mov_b32 a75, a107
    v_accvgpr_mov_b32 a76, a108
    v_accvgpr_mov_b32 a77, a109
    v_accvgpr_mov_b32 a78, a110
    v_accvgpr_mov_b32 a79, a111
    v_accvgpr_mov_b32 a80, a112
    v_accvgpr_mov_b32 a81, a113
    v_accvgpr_mov_b32 a82, a114
    v_accvgpr_mov_b32 a83, a115
    v_accvgpr_mov_b32 a84, a116
    v_accvgpr_mov_b32 a85, a117
    v_accvgpr_mov_b32 a86, a118
    v_accvgpr_mov_b32 a87, a119
    v_accvgpr_mov_b32 a88, a120
    v_accvgpr_mov_b32 a89, a121
    v_accvgpr_mov_b32 a90, a122
    v_accvgpr_mov_b32 a91, a123
    v_accvgpr_mov_b32 a92, a124
    v_accvgpr_mov_b32 a93, a125
    v_accvgpr_mov_b32 a94, a126
    v_accvgpr_mov_b32 a95, a127
L_pc4:
    v_fma_f32 v96, v64, s37, -v16
    v_fma_f32 v97, v65, s37, -v16
    v_fma_f32 v98, v66, s37, -v16
    v_fma_f32 v99, v67, s37, -v16
    v_fma_f32 v100, v68, s37, -v16
    v_fma_f32 v101, v69, s37, -v16
    v_fma_f32 v102, v70, s37, -v16
    v_fma_f32 v103, v71, s37, -v16
    v_fma_f32 v104, v72, s37, -v16
    v_fma_f32 v105, v73, s37, -v16
    v_fma_f32 v106, v74, s37, -v16
    v_fma_f32 v107, v75, s37, -v16
    v_fma_f32 v108, v76, s37, -v16
    v_fma_f32 v109, v77, s37, -v16
    v_fma_f32 v110, v78, s37, -v16
    v_fma_f32 v111, v79, s37, -v16
    v_mov_b32 v14, v6
    v_mov_b32 v17, v6
    v_mov_b32 v25, v6
    s_mov_b32 s40, 4096
    s_mov_b32 s59, 32768
    s_mov_b32 s57, 1
    s_branch L_rare
.p2align 6
L_p1T:
    v_mfma_f32_32x32x16_bf16 v[48:63], a[64:67], a[0:3], 0
    s_mov_b32 m0, s48
    s_add_u32 s35, s34, s40
    s_waitcnt vmcnt(3)
    buffer_load_dwordx4 v6, s[8:11], s34 offen offset:0 nt lds
    v_exp_f32 v80, v80
    v_mfma_f32_32x32x16_bf16 v[48:63], a[68:71], a[4:7], v[48:63]
    v_exp_f32 v81, v81
    v_exp_f32 v82, v82
    v_exp_f32 v83, v83
    v_pk_add_f32 v[18:19], v[18:19], v[80:81]
    v_cvt_pk_bf16_f32 v112, v80, v81
    v_mfma_f32_32x32x16_bf16 v[48:63], a[72:75], a[8:11], v[48:63]
    v_exp_f32 v84, v84
    v_exp_f32 v85, v85
    s_waitcnt vmcnt(3)
    buffer_load_dwordx4 v14, s[8:11], s34 offen offset:1024 nt lds
    v_pk_add_f32 v[18:19], v[18:19], v[82:83]
    v_mfma_f32_32x32x16_bf16 v[48:63], a[76:79], a[12:15], v[48:63]
    v_cvt_pk_bf16_f32 v113, v82, v83
    v_exp_f32 v86, v86
    v_exp_f32 v87, v87
    v_pk_add_f32 v[18:19], v[18:19], v[84:85]
    v_cvt_pk_bf16_f32 v114, v84, v85
    v_mfma_f32_32x32x16_bf16 v[48:63], a[80:83], a[16:19], v[48:63]
    v_exp_f32 v88, v88
    s_waitcnt vmcnt(3)
    buffer_load_dwordx4 v17, s[8:11], s34 offen offset:2048 nt lds
    v_exp_f32 v89, v89
    v_pk_add_f32 v[18:19], v[18:19], v[86:87]
    v_mfma_f32_32x32x16_bf16 v[48:63], a[84:87], a[20:23], v[48:63]
    v_cvt_pk_bf16_f32 v115, v86, v87
    v_exp_f32 v90, v90
    v_exp_f32 v91, v91
    v_pk_add_f32 v[18:19], v[18:19], v[88:89]
    v_cvt_pk_bf16_f32 v116, v88, v89
    v_exp_f32 v92, v92
    v_mfma_f32_32x32x16_bf16 v[48:63], a[88:91], a[24:27], v[48:63]
    s_waitcnt vmcnt(3)
    buffer_load_dwordx4 v25, s[8:11], s34 offen offset:3072 nt lds
    v_exp_f32 v93, v93
    v_pk_add_f32 v[18:19], v[18:19], v[90:91]
    v_mfma_f32_32x32x16_bf16 v[48:63], a[92:95], a[28:31], v[48:63]
    v_cvt_pk_bf16_f32 v117, v90, v91
    v_exp_f32 v94, v94
    v_exp_f32 v95, v95
    v_pk_add_f32 v[18:19], v[18:19], v[92:93]
    v_cvt_pk_bf16_f32 v118, v92, v93
    v_exp_f32 v96, v96
    v_mfma_f32_32x32x16_bf16 v[64:79], a[64:67], a[32:35], 0
    s_add_u32 m0, s48, 4096
    s_add_u32 s34, s34, s59
    s_waitcnt vmcnt(3)
    buffer_load_dwordx4 v6, s[8:11], s35 offen offset:0 nt lds
    v_exp_f32 v97, v97
    v_mfma_f32_32x32x16_bf16 v[64:79], a[68:71], a[36:39], v[64:79]
    v_pk_add_f32 v[18:19], v[18:19], v[94:95]
    v_cvt_pk_bf16_f32 v119, v94, v95
    v_exp_f32 v98, v98
    v_exp_f32 v99, v99
    v_pk_add_f32 v[20:21], v[20:21], v[96:97]
    v_cvt_pk_bf16_f32 v120, v96, v97
    v_mfma_f32_32x32x16_bf16 v[64:79], a[72:75], a[40:43], v[64:79]
    v_exp_f32 v100, v100
    s_waitcnt vmcnt(3)
    buffer_load_dwordx4 v14, s[8:11], s35 offen offset:1024 nt lds
    v_exp_f32 v101, v101
    v_mfma_f32_32x32x16_bf16 v[64:79], a[76:79], a[44:47], v[64:79]
    v_pk_add_f32 v[20:21], v[20:21], v[98:99]
    v_cvt_pk_bf16_f32 v121, v98, v99
    v_exp_f32 v102, v102
    v_exp_f32 v103, v103
    v_pk_add_f32 v[20:21], v[20:21], v[100:101]
    v_cvt_pk_bf16_f32 v122, v100, v101
    v_mfma_f32_32x32x16_bf16 v[64:79], a[80:83], a[48:51], v[64:79]
    v_exp_f32 v104, v104
    s_waitcnt vmcnt(3)
    buffer_load_dwordx4 v17, s[8:11], s35 offen offset:2048 nt lds
    v_exp_f32 v105, v105
    v_mfma_f32_32x32x16_bf16 v[64:79], a[84:87], a[52:55], v[64:79]
    v_pk_add_f32 v[20:21], v[20:21], v[102:103]
    v_cvt_pk_bf16_f32 v123, v102, v103
    v_exp_f32 v106, v106
    v_exp_f32 v107, v107
    v_pk_add_f32 v[20:21], v[20:21], v[104:105]
    v_cvt_pk_bf16_f32 v124, v104, v105
    v_mfma_f32_32x32x16_bf16 v[64:79], a[88:91], a[56:59], v[64:79]
    v_exp_f32 v108, v108
    s_waitcnt vmcnt(3)
    buffer_load_dwordx4 v25, s[8:11], s35 offen offset:3072 nt lds
    v_exp_f32 v109, v109
    v_mfma_f32_32x32x16_bf16 v[64:79], a[92:95], a[60:63], v[64:79]
    v_pk_add_f32 v[20:21], v[20:21], v[106:107]
    v_cvt_pk_bf16_f32 v125, v106, v107
    v_exp_f32 v110, v110
    v_exp_f32 v111, v111
    v_pk_add_f32 v[20:21], v[20:21], v[108:109]
    v_cvt_pk_bf16_f32 v126, v108, v109
    v_pk_add_f32 v[20:21], v[20:21], v[110:111]
    v_cvt_pk_bf16_f32 v127, v110, v111
    s_branch L_j1
L_p2T:
    v_mfma_f32_32x32x16_bf16 v[192:207], a[112:115], v[112:115], v[192:207]
    s_mov_b32 s52, s30
    s_mov_b32 m0, s52
    s_add_u32 s35, s33, s86
    s_waitcnt vmcnt(3)
    buffer_load_dwordx4 v2, s[4:7], s33 offen offset:0 nt lds
    v_mfma_f32_32x32x16_bf16 v[208:223], a[112:115], v[120:123], v[208:223]
    s_add_u32 s30, s30, 8192
    s_cmp_ge_u32 s30, s32
    s_cselect_b32 s30, s31, s30
    v_max3_f32 v28, v80, v81, v82
    v_max3_f32 v29, v96, v97, v98
    v_max3_f32 v28, v28, v83, v84
    s_waitcnt vmcnt(3)
    v_mfma_f32_32x32x16_bf16 v[224:239], a[120:123], v[112:115], v[224:239]
    buffer_load_dwordx4 v3, s[4:7], s33 offen offset:1024 nt lds
    v_max3_f32 v29, v29, v99, v100
    v_max3_f32 v28, v28, v85, v86
    v_max3_f32 v29, v29, v101, v102
    v_max3_f32 v28, v28, v87, v88
    v_mfma_f32_32x32x16_bf16 v[240:255], a[120:123], v[120:123], v[240:255]
    v_max3_f32 v29, v29, v103, v104
    v_max3_f32 v28, v28, v89, v90
    s_waitcnt vmcnt(3)
    buffer_load_dwordx4 v4, s[4:7], s33 offen offset:2048 nt lds
    v_max3_f32 v29, v29, v105, v106
    v_mfma_f32_32x32x16_bf16 v[128:143], a[100:103], v[116:119], v[128:143]
    v_max3_f32 v28, v28, v91, v92
    v_max3_f32 v29, v29, v107, v108
    v_max3_f32 v28, v28, v93, v94
    v_max3_f32 v29, v29, v109, v110
    s_bitcmp1_b32 s46, s29
    s_cbranch_scc1 L_w_3
    s_waitcnt vmcnt(11)
L_w_3:
    s_waitcnt vmcnt(19)
    v_mfma_f32_32x32x16_bf16 v[144:159], a[100:103], v[124:127], v[144:159]
    s_waitcnt vmcnt(3)
    buffer_load_dwordx4 v5, s[4:7], s33 offen offset:3072 nt lds
    s_mov_b32 s48, s30
    v_add_u32 v40, s30, v11
    ds_read_b128 a[64:67], v40
    v_mfma_f32_32x32x16_bf16 v[160:175], a[108:111], v[116:119], v[160:175]
    s_add_u32 m0, s52, 4096
    s_add_u32 s33, s33, s87
    s_waitcnt vmcnt(3)
    buffer_load_dwordx4 v2, s[4:7], s35 offen offset:0 nt lds
    v_xor_b32 v41, 32, v40
    v_mfma_f32_32x32x16_bf16 v[176:191], a[108:111], v[124:127], v[176:191]
    ds_read_b128 a[68:71], v41
    v_xor_b32 v42, 64, v40
    ds_read_b128 a[72:75], v42
    v_xor_b32 v43, 96, v40
    s_waitcnt vmcnt(3)
    v_mfma_f32_32x32x16_bf16 v[192:207], a[116:119], v[116:119], v[192:207]
    buffer_load_dwordx4 v3, s[4:7], s35 offen offset:1024 nt lds
    ds_read_b128 a[76:79], v43
    v_xor_b32 v44, 128, v40
    ds_read_b128 a[80:83], v44
    v_xor_b32 v45, 160, v40
    v_mfma_f32_32x32x16_bf16 v[208:223], a[116:119], v[124:127], v[208:223]
    ds_read_b128 a[84:87], v45
    s_waitcnt vmcnt(3)
    buffer_load_dwordx4 v4, s[4:7], s35 offen offset:2048 nt lds
    v_xor_b32 v46, 192, v40
    v_mfma_f32_32x32x16_bf16 v[224:239], a[124:127], v[116:119], v[224:239]
    ds_read_b128 a[88:91], v46
    v_xor_b32 v47, 224, v40
    ds_read_b128 a[92:95], v47
    s_add_u32 s30, s30, 8192
    s_waitcnt vmcnt(3)
    v_mfma_f32_32x32x16_bf16 v[240:255], a[124:127], v[124:127], v[240:255]
    buffer_load_dwordx4 v5, s[4:7], s35 offen offset:3072 nt lds
    s_cmp_ge_u32 s30, s32
    s_cselect_b32 s30, s31, s30
    v_max3_f32 v28, v28, v95, v111
    v_max_f32 v28, v28, v29
    v_cmp_lt_f32 vcc, s58, v28
    s_branch L_join
.p2align 6
L_loop:
    s_waitcnt lgkmcnt(0)
    s_cmp_lg_u32 s72, 0
    s_cbranch_scc1 L_p1T
    v_mfma_f32_32x32x16_bf16 v[48:63], a[64:67], a[0:3], 0
    s_mov_b32 m0, s48
    s_add_u32 s35, s34, s40
    s_waitcnt vmcnt(11)
    buffer_load_dwordx4 v6, s[8:11], s34 offen offset:0 nt lds
    v_exp_f32 v80, v80
    v_mfma_f32_32x32x16_bf16 v[48:63], a[68:71], a[4:7], v[48:63]
    v_exp_f32 v81, v81
    v_exp_f32 v82, v82
    v_exp_f32 v83, v83
    v_pk_add_f32 v[18:19], v[18:19], v[80:81]
    v_cvt_pk_bf16_f32 v112, v80, v81
    v_mfma_f32_32x32x16_bf16 v[48:63], a[72:75], a[8:11], v[48:63]
    v_exp_f32 v84, v84
    v_exp_f32 v85, v85
    s_waitcnt vmcnt(11)
    buffer_load_dwordx4 v14, s[8:11], s34 offen offset:1024 nt lds
    v_pk_add_f32 v[18:19], v[18:19], v[82:83]
    v_mfma_f32_32x32x16_bf16 v[48:63], a[76:79], a[12:15], v[48:63]
    v_cvt_pk_bf16_f32 v113, v82, v83
    v_exp_f32 v86, v86
    v_exp_f32 v87, v87
    v_pk_add_f32 v[18:19], v[18:19], v[84:85]
    v_cvt_pk_bf16_f32 v114, v84, v85
    v_mfma_f32_32x32x16_bf16 v[48:63], a[80:83], a[16:19], v[48:63]
    v_exp_f32 v88, v88
    s_waitcnt vmcnt(11)
    buffer_load_dwordx4 v17, s[8:11], s34 offen offset:2048 nt lds
    v_exp_f32 v89, v89
    v_pk_add_f32 v[18:19], v[18:19], v[86:87]
    v_mfma_f32_32x32x16_bf16 v[48:63], a[84:87], a[20:23], v[48:63]
    v_cvt_pk_bf16_f32 v115, v86, v87
    v_exp_f32 v90, v90
    v_exp_f32 v91, v91
    v_pk_add_f32 v[18:19], v[18:19], v[88:89]
    v_cvt_pk_bf16_f32 v116, v88, v89
    v_exp_f32 v92, v92
    v_mfma_f32_32x32x16_bf16 v[48:63], a[88:91], a[24:27], v[48:63]
    s_waitcnt vmcnt(11)
    buffer_load_dwordx4 v25, s[8:11], s34 offen offset:3072 nt lds
    v_exp_f32 v93, v93
    v_pk_add_f32 v[18:19], v[18:19], v[90:91]
    v_mfma_f32_32x32x16_bf16 v[48:63], a[92:95], a[28:31], v[48:63]
    v_cvt_pk_bf16_f32 v117, v90, v91
    v_exp_f32 v94, v94
    v_exp_f32 v95, v95
    v_pk_add_f32 v[18:19], v[18:19], v[92:93]
    v_cvt_pk_bf16_f32 v118, v92, v93
    v_exp_f32 v96, v96
    v_mfma_f32_32x32x16_bf16 v[64:79], a[64:67], a[32:35], 0
    s_add_u32 m0, s48, 4096
    s_add_u32 s34, s34, s59
    s_waitcnt vmcnt(11)
    buffer_load_dwordx4 v6, s[8:11], s35 offen offset:0 nt lds
    v_exp_f32 v97, v97
    v_mfma_f32_32x32x16_bf16 v[64:79], a[68:71], a[36:39], v[64:79]
    v_pk_add_f32 v[18:19], v[18:19], v[94:95]
    v_cvt_pk_bf16_f32 v119, v94, v95
    v_exp_f32 v98, v98
    v_exp_f32 v99, v99
    v_pk_add_f32 v[20:21], v[20:21], v[96:97]
    v_cvt_pk_bf16_f32 v120, v96, v97
    v_mfma_f32_32x32x16_bf16 v[64:79], a[72:75], a[40:43], v[64:79]
    v_exp_f32 v100, v100
    s_waitcnt vmcnt(11)
    buffer_load_dwordx4 v14, s[8:11], s35 offen offset:1024 nt lds
    v_exp_f32 v101, v101
    v_mfma_f32_32x32x16_bf16 v[64:79], a[76:79], a[44:47], v[64:79]
    v_pk_add_f32 v[20:21], v[20:21], v[98:99]
    v_cvt_pk_bf16_f32 v121, v98, v99
    v_exp_f32 v102, v102
    v_exp_f32 v103, v103
    v_pk_add_f32 v[20:21], v[20:21], v[100:101]
    v_cvt_pk_bf16_f32 v122, v100, v101
    v_mfma_f32_32x32x16_bf16 v[64:79], a[80:83], a[48:51], v[64:79]
    v_exp_f32 v104, v104
    s_waitcnt vmcnt(11)
    buffer_load_dwordx4 v17, s[8:11], s35 offen offset:2048 nt lds
    v_exp_f32 v105, v105
    v_mfma_f32_32x32x16_bf16 v[64:79], a[84:87], a[52:55], v[64:79]
    v_pk_add_f32 v[20:21], v[20:21], v[102:103]
    v_cvt_pk_bf16_f32 v123, v102, v103
    v_exp_f32 v106, v106
    v_exp_f32 v107, v107
    v_pk_add_f32 v[20:21], v[20:21], v[104:105]
    v_cvt_pk_bf16_f32 v124, v104, v105
    v_mfma_f32_32x32x16_bf16 v[64:79], a[88:91], a[56:59], v[64:79]
    v_exp_f32 v108, v108
    s_waitcnt vmcnt(11)
    buffer_load_dwordx4 v25, s[8:11], s35 offen offset:3072 nt lds
    v_exp_f32 v109, v109
    v_mfma_f32_32x32x16_bf16 v[64:79], a[92:95], a[60:63], v[64:79]
    v_pk_add_f32 v[20:21], v[20:21], v[106:107]
    v_cvt_pk_bf16_f32 v125, v106, v107
    v_exp_f32 v110, v110
    v_exp_f32 v111, v111
    v_pk_add_f32 v[20:21], v[20:21], v[108:109]
    v_cvt_pk_bf16_f32 v126, v108, v109
    v_pk_add_f32 v[20:21], v[20:21], v[110:111]
    v_cvt_pk_bf16_f32 v127, v110, v111
L_j1:
    s_bitcmp1_b32 s46, s29
    s_cbranch_scc1 L_w_4
    s_waitcnt vmcnt(16)
L_w_4:
    s_waitcnt vmcnt(24)
    v_add_u32 v32, s30, v12
    v_xor_b32 v33, 64, v32
    v_xor_b32 v34, 128, v32
    v_xor_b32 v35, 192, v32
    ds_read_b64_tr_b16 a[96:97], v32 offset:0
    ds_read_b64_tr_b16 a[98:99], v32 offset:1024
    ds_read_b64_tr_b16 a[104:105], v33 offset:0
    ds_read_b64_tr_b16 a[106:107], v33 offset:1024
    ds_read_b64_tr_b16 a[112:113], v34 offset:0
    ds_read_b64_tr_b16 a[114:115], v34 offset:1024
    ds_read_b64_tr_b16 a[120:121], v35 offset:0
    ds_read_b64_tr_b16 a[122:123], v35 offset:1024
    ds_read_b64_tr_b16 a[100:101], v32 offset:4096
    ds_read_b64_tr_b16 a[102:103], v32 offset:5120
    ds_read_b64_tr_b16 a[108:109], v33 offset:4096
    ds_read_b64_tr_b16 a[110:111], v33 offset:5120
    ds_read_b64_tr_b16 a[116:117], v34 offset:4096
    ds_read_b64_tr_b16 a[118:119], v34 offset:5120
    ds_read_b64_tr_b16 a[124:125], v35 offset:4096
    ds_read_b64_tr_b16 a[126:127], v35 offset:5120
    v_fma_f32 v80, v48, s37, -v15
    v_fma_f32 v81, v49, s37, -v15
    v_fma_f32 v82, v50, s37, -v15
    v_fma_f32 v83, v51, s37, -v15
    v_fma_f32 v84, v52, s37, -v15
    v_fma_f32 v85, v53, s37, -v15
    v_fma_f32 v86, v54, s37, -v15
    v_fma_f32 v87, v55, s37, -v15
    v_fma_f32 v88, v56, s37, -v15
    v_fma_f32 v89, v57, s37, -v15
    v_fma_f32 v90, v58, s37, -v15
    v_fma_f32 v91, v59, s37, -v15
    v_fma_f32 v92, v60, s37, -v15
    v_fma_f32 v93, v61, s37, -v15
    v_fma_f32 v94, v62, s37, -v15
    v_fma_f32 v95, v63, s37, -v15
    s_waitcnt lgkmcnt(14)
    v_mfma_f32_32x32x16_bf16 v[128:143], a[96:99], v[112:115], v[128:143]
    v_fma_f32 v96, v64, s37, -v16
    v_fma_f32 v97, v65, s37, -v16
    v_fma_f32 v98, v66, s37, -v16
    v_fma_f32 v99, v67, s37, -v16
    v_mfma_f32_32x32x16_bf16 v[144:159], a[96:99], v[120:123], v[144:159]
    v_fma_f32 v100, v68, s37, -v16
    v_fma_f32 v101, v69, s37, -v16
    v_fma_f32 v102, v70, s37, -v16
    v_fma_f32 v103, v71, s37, -v16
    s_waitcnt lgkmcnt(12)
    v_mfma_f32_32x32x16_bf16 v[160:175], a[104:107], v[112:115], v[160:175]
    v_fma_f32 v104, v72, s37, -v16
    v_fma_f32 v105, v73, s37, -v16
    v_fma_f32 v106, v74, s37, -v16
    v_fma_f32 v107, v75, s37, -v16
    v_mfma_f32_32x32x16_bf16 v[176:191], a[104:107], v[120:123], v[176:191]
    v_fma_f32 v108, v76, s37, -v16
    v_fma_f32 v109, v77, s37, -v16
    v_fma_f32 v110, v78, s37, -v16
    v_fma_f32 v111, v79, s37, -v16
    s_waitcnt lgkmcnt(0)
    s_cmp_lg_u32 s72, 0
    s_cbranch_scc1 L_p2T
    v_mfma_f32_32x32x16_bf16 v[192:207], a[112:115], v[112:115], v[192:207]
    s_mov_b32 s52, s30
    s_mov_b32 m0, s52
    s_add_u32 s35, s33, s86
    s_waitcnt vmcnt(11)
    buffer_load_dwordx4 v2, s[4:7], s33 offen offset:0 nt lds
    v_mfma_f32_32x32x16_bf16 v[208:223], a[112:115], v[120:123], v[208:223]
    s_add_u32 s30, s30, 8192
    s_cmp_ge_u32 s30, s32
    s_cselect_b32 s30, s31, s30
    v_max3_f32 v28, v80, v81, v82
    v_max3_f32 v29, v96, v97, v98
    v_max3_f32 v28, v28, v83, v84
    s_waitcnt vmcnt(11)
    v_mfma_f32_32x32x16_bf16 v[224:239], a[120:123], v[112:115], v[224:239]
    buffer_load_dwordx4 v3, s[4:7], s33 offen offset:1024 nt lds
    v_max3_f32 v29, v29, v99, v100
    v_max3_f32 v28, v28, v85, v86
    v_max3_f32 v29, v29, v101, v102
    v_max3_f32 v28, v28, v87, v88
    v_mfma_f32_32x32x16_bf16 v[240:255], a[120:123], v[120:123], v[240:255]
    v_max3_f32 v29, v29, v103, v104
    v_max3_f32 v28, v28, v89, v90
    s_waitcnt vmcnt(11)
    buffer_load_dwordx4 v4, s[4:7], s33 offen offset:2048 nt lds
    v_max3_f32 v29, v29, v105, v106
    v_mfma_f32_32x32x16_bf16 v[128:143], a[100:103], v[116:119], v[128:143]
    v_max3_f32 v28, v28, v91, v92
    v_max3_f32 v29, v29, v107, v108
    v_max3_f32 v28, v28, v93, v94
    v_max3_f32 v29, v29, v109, v110
    s_bitcmp1_b32 s46, s29
    s_cbranch_scc1 L_w_6
    s_waitcnt vmcnt(11)
L_w_6:
    s_waitcnt vmcnt(19)
    v_mfma_f32_32x32x16_bf16 v[144:159], a[100:103], v[124:127], v[144:159]
    s_waitcnt vmcnt(11)
    buffer_load_dwordx4 v5, s[4:7], s33 offen offset:3072 nt lds
    s_mov_b32 s48, s30
    v_add_u32 v40, s30, v11
    ds_read_b128 a[64:67], v40
    v_mfma_f32_32x32x16_bf16 v[160:175], a[108:111], v[116:119], v[160:175]
    s_add_u32 m0, s52, 4096
    s_add_u32 s33, s33, s87
    s_waitcnt vmcnt(11)
    buffer_load_dwordx4 v2, s[4:7], s35 offen offset:0 nt lds
    v_xor_b32 v41, 32, v40
    v_mfma_f32_32x32x16_bf16 v[176:191], a[108:111], v[124:127], v[176:191]
    ds_read_b128 a[68:71], v41
    v_xor_b32 v42, 64, v40
    ds_read_b128 a[72:75], v42
    v_xor_b32 v43, 96, v40
    s_waitcnt vmcnt(11)
    v_mfma_f32_32x32x16_bf16 v[192:207], a[116:119], v[116:119], v[192:207]
    buffer_load_dwordx4 v3, s[4:7], s35 offen offset:1024 nt lds
    ds_read_b128 a[76:79], v43
    v_xor_b32 v44, 128, v40
    ds_read_b128 a[80:83], v44
    v_xor_b32 v45, 160, v40
    v_mfma_f32_32x32x16_bf16 v[208:223], a[116:119], v[124:127], v[208:223]
    ds_read_b128 a[84:87], v45
    s_waitcnt vmcnt(11)
    buffer_load_dwordx4 v4, s[4:7], s35 offen offset:2048 nt lds
    v_xor_b32 v46, 192, v40
    v_mfma_f32_32x32x16_bf16 v[224:239], a[124:127], v[116:119], v[224:239]
    ds_read_b128 a[88:91], v46
    v_xor_b32 v47, 224, v40
    ds_read_b128 a[92:95], v47
    s_add_u32 s30, s30, 8192
    s_waitcnt vmcnt(11)
    v_mfma_f32_32x32x16_bf16 v[240:255], a[124:127], v[124:127], v[240:255]
    buffer_load_dwordx4 v5, s[4:7], s35 offen offset:3072 nt lds
    s_cmp_ge_u32 s30, s32
    s_cselect_b32 s30, s31, s30
    v_max3_f32 v28, v28, v95, v111
    v_max_f32 v28, v28, v29
    v_cmp_lt_f32 vcc, s58, v28
L_join:
    s_and_b32 s36, s29, 15
    s_cmp_eq_u32 s36, 15
    s_cbranch_scc1 L_combine
    s_cbranch_vccnz L_rare
L_rare_ret:
    s_bitcmp1_b32 s56, s29
    s_cbranch_scc0 L_noside
    s_bitcmp1_b32 s46, s29
    s_cbranch_scc0 L_issue
    s_waitcnt vmcnt(16)
    s_bitcmp1_b32 s42, s29
    s_cbranch_scc0 L_consV
    v_add_u32 v32, s38, v13
    v_xor_b32 v33, 64, v32
    ds_read_b64_tr_b16 a[96:97], v32 offset:0
    ds_read_b64_tr_b16 a[98:99], v32 offset:512
    ds_read_b64_tr_b16 a[100:101], v33 offset:0
    ds_read_b64_tr_b16 a[102:103], v33 offset:512
    ds_read_b64_tr_b16 a[104:105], v32 offset:2048
    ds_read_b64_tr_b16 a[106:107], v32 offset:2560
    ds_read_b64_tr_b16 a[108:109], v33 offset:2048
    ds_read_b64_tr_b16 a[110:111], v33 offset:2560
    ds_read_b64_tr_b16 a[112:113], v32 offset:4096
    ds_read_b64_tr_b16 a[114:115], v32 offset:4608
    ds_read_b64_tr_b16 a[116:117], v33 offset:4096
    ds_read_b64_tr_b16 a[118:119], v33 offset:4608
    ds_read_b64_tr_b16 a[120:121], v32 offset:6144
    ds_read_b64_tr_b16 a[122:123], v32 offset:6656
    ds_read_b64_tr_b16 a[124:125], v33 offset:6144
    ds_read_b64_tr_b16 a[126:127], v33 offset:6656
    s_bitcmp1_b32 s43, s29
    s_cbranch_scc0 L_noxrd
    s_and_b32 s35, s47, 1
    s_lshl_b32 s35, s35, 7
    s_lshr_b32 s36, s47, 1
    s_lshl_b32 s36, s36, 13
    v_xor_b32 v34, s35, v10
    v_add_u32 v34, s36, v34
    s_add_u32 s47, s47, 1
    ds_read_b128 a[224:227], v34
    v_xor_b32 v35, 32, v34
    ds_read_b128 a[228:231], v35
    v_xor_b32 v36, 64, v34
    ds_read_b128 a[232:235], v36
    v_xor_b32 v37, 96, v34
    ds_read_b128 a[236:239], v37
L_noxrd:
    s_waitcnt lgkmcnt(0)
    v_mfma_f32_32x32x16_bf16 a[192:207], a[96:99], a[224:227], a[192:207]
    v_mfma_f32_32x32x16_bf16 a[208:223], a[100:103], a[224:227], a[208:223]
    v_mfma_f32_32x32x16_bf16 a[192:207], a[104:107], a[228:231], a[192:207]
    v_mfma_f32_32x32x16_bf16 a[208:223], a[108:111], a[228:231], a[208:223]
    v_mfma_f32_32x32x16_bf16 a[192:207], a[112:115], a[232:235], a[192:207]
    v_mfma_f32_32x32x16_bf16 a[208:223], a[116:119], a[232:235], a[208:223]
    v_mfma_f32_32x32x16_bf16 a[192:207], a[120:123], a[236:239], a[192:207]
    v_mfma_f32_32x32x16_bf16 a[208:223], a[124:127], a[236:239], a[208:223]
    s_branch L_issue
L_consV:
    v_add_u32 v32, s38, v12
    v_xor_b32 v33, 64, v32
    v_xor_b32 v34, 128, v32
    v_xor_b32 v35, 192, v32
    ds_read_b64_tr_b16 a[96:97], v32 offset:0
    ds_read_b64_tr_b16 a[98:99], v32 offset:1024
    ds_read_b64_tr_b16 a[104:105], v33 offset:0
    ds_read_b64_tr_b16 a[106:107], v33 offset:1024
    ds_read_b64_tr_b16 a[112:113], v34 offset:0
    ds_read_b64_tr_b16 a[114:115], v34 offset:1024
    ds_read_b64_tr_b16 a[120:121], v35 offset:0
    ds_read_b64_tr_b16 a[122:123], v35 offset:1024
    ds_read_b64_tr_b16 a[100:101], v32 offset:4096
    ds_read_b64_tr_b16 a[102:103], v32 offset:5120
    ds_read_b64_tr_b16 a[108:109], v33 offset:4096
    ds_read_b64_tr_b16 a[110:111], v33 offset:5120
    ds_read_b64_tr_b16 a[116:117], v34 offset:4096
    ds_read_b64_tr_b16 a[118:119], v34 offset:5120
    ds_read_b64_tr_b16 a[124:125], v35 offset:4096
    ds_read_b64_tr_b16 a[126:127], v35 offset:5120
    s_lshl_b32 s35, s47, 11
    s_add_u32 s35, s35, 131072
    v_add_u32 v36, s35, v1
    ds_read_b128 a[224:227], v36
    ds_read_b128 a[228:231], v36 offset:1024
    s_add_u32 s47, s47, 1
    s_waitcnt lgkmcnt(0)
    v_mfma_f32_32x32x16_bf16 a[128:143], a[96:99], a[224:227], a[128:143]
    v_mfma_f32_32x32x16_bf16 a[144:159], a[104:107], a[224:227], a[144:159]
    v_mfma_f32_32x32x16_bf16 a[160:175], a[112:115], a[224:227], a[160:175]
    v_mfma_f32_32x32x16_bf16 a[176:191], a[120:123], a[224:227], a[176:191]
    v_mfma_f32_32x32x16_bf16 a[128:143], a[100:103], a[228:231], a[128:143]
    v_mfma_f32_32x32x16_bf16 a[144:159], a[108:111], a[228:231], a[144:159]
    v_mfma_f32_32x32x16_bf16 a[160:175], a[116:119], a[228:231], a[160:175]
    v_mfma_f32_32x32x16_bf16 a[176:191], a[124:127], a[228:231], a[176:191]
L_issue:
    s_bitcmp1_b32 s44, s29
    s_cbranch_scc0 L_issVo
    s_mov_b32 m0, s38
    s_add_u32 s35, s39, 0
    buffer_load_dwordx4 v7, s[12:15], s35 offen offset:0  lds
    s_add_u32 s35, s39, 64512
    buffer_load_dwordx4 v7, s[12:15], s35 offen offset:1024  lds
    s_add_u32 s35, s39, 129024
    buffer_load_dwordx4 v7, s[12:15], s35 offen offset:2048  lds
    s_add_u32 s35, s39, 193536
    buffer_load_dwordx4 v7, s[12:15], s35 offen offset:3072  lds
    s_add_u32 m0, s38, 4096
    s_add_u32 s35, s39, 262144
    buffer_load_dwordx4 v7, s[12:15], s35 offen offset:0  lds
    s_add_u32 s35, s39, 326656
    buffer_load_dwordx4 v7, s[12:15], s35 offen offset:1024  lds
    s_add_u32 s35, s39, 391168
    buffer_load_dwordx4 v7, s[12:15], s35 offen offset:2048  lds
    s_add_u32 s35, s39, 455680
    buffer_load_dwordx4 v7, s[12:15], s35 offen offset:3072  lds
    s_add_u32 s39, s39, 524288
    s_branch L_noside
L_issVo:
    s_bitcmp1_b32 s45, s29
    s_cbranch_scc0 L_noside
    s_mov_b32 m0, s38
    s_add_u32 s35, s41, 0
    buffer_load_dwordx4 v8, s[16:19], s35 offen offset:0  lds
    s_add_u32 s35, s41, 3584
    buffer_load_dwordx4 v8, s[16:19], s35 offen offset:1024  lds
    s_add_u32 s35, s41, 7168
    buffer_load_dwordx4 v8, s[16:19], s35 offen offset:2048  lds
    s_add_u32 s35, s41, 10752
    buffer_load_dwordx4 v8, s[16:19], s35 offen offset:3072  lds
    s_add_u32 m0, s38, 4096
    s_add_u32 s35, s41, 18432
    buffer_load_dwordx4 v8, s[16:19], s35 offen offset:0  lds
    s_add_u32 s35, s41, 22016
    buffer_load_dwordx4 v8, s[16:19], s35 offen offset:1024  lds
    s_add_u32 s35, s41, 25600
    buffer_load_dwordx4 v8, s[16:19], s35 offen offset:2048  lds
    s_add_u32 s35, s41, 29184
    buffer_load_dwordx4 v8, s[16:19], s35 offen offset:3072  lds
    s_add_u32 s41, s41, 36864
L_noside:
    v_subrev_u32 v33, s75, v31
    s_add_u32 s36, s29, 1
    s_add_u32 s36, s36, s75
    v_readlane_b32 s35, v33, s93
    v_mov_b32 v32, s36
    v_lshlrev_b32 v34, 3, v1
    v_cmp_gt_u32 vcc, s35, v33
    v_lshrrev_b32 v35, 2, v1
    buffer_store_dword v32, v34, s[76:79], s94 offen
    buffer_load_dword v31, v35, s[76:79], 0 offen sc1
    s_cmp_gt_u32 s35, 128
    s_cselect_b32 vcc_lo, 0, vcc_lo
    s_bcnt1_i32_b32 s35, vcc_lo
    s_cmp_ge_u32 s35, s95
    s_cselect_b32 s72, 1, 0
    s_bitcmp1_b32 s55, s29
    s_cbranch_scc1 L_special
L_spec_ret:
    s_mov_b32 s35, 357913941
    s_bitcmp1_b32 s35, s29
    s_cbranch_scc0 L_nobar
    s_barrier
L_nobar:
    s_add_u32 s29, s29, 1
    s_branch L_loop
L_special:
    s_lshl_b32 s36, s93, 2
    s_add_u32 s36, s36, s28
    v_lshrrev_b32 v32, 4, v1
    s_cmp_lg_u32 s29, s100
    s_cbranch_scc1 L_sq1
    s_mul_i32 s35, s36, 18
    v_add_u32 v33, s35, v32
    v_lshrrev_b32 v34, 2, v33
    v_and_b32 v33, 3, v33
    v_lshlrev_b32 v33, 7, v33
    v_lshl_add_u32 v33, v34, 13, v33
    s_lshl_b32 s35, s92, 10
    s_add_u32 s35, s35, 512
    s_mov_b64 exec, 0x3ffff
    buffer_load_dword v30, v33, s[12:15], s35 offen nt
    buffer_load_dword v30, v33, s[12:15], s35 offen
L_sq1e:
    s_mov_b64 exec, -1
L_sq1:
    s_cmp_lg_u32 s29, s101
    s_cbranch_scc1 L_sq2
    s_mul_i32 s35, s36, 4608
    s_mul_i32 s36, s92, 589824
    s_add_u32 s35, s35, s36
    v_lshlrev_b32 v33, 7, v32
    s_mov_b32 exec_hi, 0xf
    buffer_load_dword v30, v33, s[16:19], s35 offen nt
    buffer_load_dword v30, v33, s[16:19], s35 offen
L_sq2e:
    s_mov_b64 exec, -1
L_sq2:
    s_bitcmp1_b32 s73, s29
    s_cbranch_scc0 L_spec_ret
    s_and_b32 s36, s29, 15
    s_cbranch_scc1 L_sq3
    s_cmp_eq_u32 s29, 0
    s_cselect_b32 s34, s74, s34
    s_cmp_eq_u32 s29, 16
    s_cbranch_scc1 L_spec_ret
L_sq3:
    s_cmp_eq_u32 s29, 3
    s_cbranch_scc1 L_sp3
    s_cmp_eq_u32 s29, 20
    s_cbranch_scc1 L_sp20
    s_cmp_eq_u32 s29, 26
    s_cbranch_scc1 L_sp26
    s_cmp_eq_u32 s29, 27
    s_cbranch_scc1 L_sp27
    s_cmp_eq_u32 s29, 28
    s_cbranch_scc1 L_sp28
    s_cmp_eq_u32 s29, 29
    s_cbranch_scc1 L_sp29
    s_cmp_eq_u32 s29, 30
    s_cbranch_scc1 L_sp30
    s_waitcnt lgkmcnt(0)
    s_barrier
    s_cmp_eq_u32 s29, 14
    s_cbranch_scc1 L_sp14
    s_cmp_lg_u32 s29, 13
    s_cbranch_scc1 L_spec_ret
    v_accvgpr_read_b32 v48, a192
    v_accvgpr_read_b32 v49, a193
    v_accvgpr_read_b32 v50, a194
    v_accvgpr_read_b32 v51, a195
    v_accvgpr_read_b32 v52, a196
    v_accvgpr_read_b32 v53, a197
    v_accvgpr_read_b32 v54, a198
    v_accvgpr_read_b32 v55, a199
    v_accvgpr_read_b32 v56, a200
    v_accvgpr_read_b32 v57, a201
    v_accvgpr_read_b32 v58, a202
    v_accvgpr_read_b32 v59, a203
    v_accvgpr_read_b32 v60, a204
    v_accvgpr_read_b32 v61, a205
    v_accvgpr_read_b32 v62, a206
    v_accvgpr_read_b32 v63, a207
    v_accvgpr_read_b32 v64, a208
    v_accvgpr_read_b32 v65, a209
    v_accvgpr_read_b32 v66, a210
    v_accvgpr_read_b32 v67, a211
    v_accvgpr_read_b32 v68, a212
    v_accvgpr_read_b32 v69, a213
    v_accvgpr_read_b32 v70, a214
    v_accvgpr_read_b32 v71, a215
    v_accvgpr_read_b32 v72, a216
    v_accvgpr_read_b32 v73, a217
    v_accvgpr_read_b32 v74, a218
    v_accvgpr_read_b32 v75, a219
    v_accvgpr_read_b32 v76, a220
    v_accvgpr_read_b32 v77, a221
    v_accvgpr_read_b32 v78, a222
    v_accvgpr_read_b32 v79, a223
    v_cvt_pk_bf16_f32 v48, v48, v49
    v_cvt_pk_bf16_f32 v49, v50, v51
    v_cvt_pk_bf16_f32 v50, v52, v53
    v_cvt_pk_bf16_f32 v51, v54, v55
    v_cvt_pk_bf16_f32 v52, v56, v57
    v_cvt_pk_bf16_f32 v53, v58, v59
    v_cvt_pk_bf16_f32 v54, v60, v61
    v_cvt_pk_bf16_f32 v55, v62, v63
    v_cvt_pk_bf16_f32 v56, v64, v65
    v_cvt_pk_bf16_f32 v57, v66, v67
    v_cvt_pk_bf16_f32 v58, v68, v69
    v_cvt_pk_bf16_f32 v59, v70, v71
    v_cvt_pk_bf16_f32 v60, v72, v73
    v_cvt_pk_bf16_f32 v61, v74, v75
    v_cvt_pk_bf16_f32 v62, v76, v77
    v_cvt_pk_bf16_f32 v63, v78, v79
    v_add_u32 v32, s49, v1
    ds_write_b128 v32, v[48:51] offset:0
    ds_write_b128 v32, v[52:55] offset:1024
    ds_write_b128 v32, v[56:59] offset:2048
    ds_write_b128 v32, v[60:63] offset:3072
    v_accvgpr_write_b32 a128, 0
    v_accvgpr_write_b32 a129, 0
    v_accvgpr_write_b32 a130, 0
    v_accvgpr_write_b32 a131, 0
    v_accvgpr_write_b32 a132, 0
    v_accvgpr_write_b32 a133, 0
    v_accvgpr_write_b32 a134, 0
    v_accvgpr_write_b32 a135, 0
    v_accvgpr_write_b32 a136, 0
    v_accvgpr_write_b32 a137, 0
    v_accvgpr_write_b32 a138, 0
    v_accvgpr_write_b32 a139, 0
    v_accvgpr_write_b32 a140, 0
    v_accvgpr_write_b32 a141, 0
    v_accvgpr_write_b32 a142, 0
    v_accvgpr_write_b32 a143, 0
    v_accvgpr_write_b32 a144, 0
    v_accvgpr_write_b32 a145, 0
    v_accvgpr_write_b32 a146, 0
    v_accvgpr_write_b32 a147, 0
    v_accvgpr_write_b32 a148, 0
    v_accvgpr_write_b32 a149, 0
    v_accvgpr_write_b32 a150, 0
    v_accvgpr_write_b32 a151, 0
    v_accvgpr_write_b32 a152, 0
    v_accvgpr_write_b32 a153, 0
    v_accvgpr_write_b32 a154, 0
    v_accvgpr_write_b32 a155, 0
    v_accvgpr_write_b32 a156, 0
    v_accvgpr_write_b32 a157, 0
    v_accvgpr_write_b32 a158, 0
    v_accvgpr_write_b32 a159, 0
    v_accvgpr_write_b32 a160, 0
    v_accvgpr_write_b32 a161, 0
    v_accvgpr_write_b32 a162, 0
    v_accvgpr_write_b32 a163, 0
    v_accvgpr_write_b32 a164, 0
    v_accvgpr_write_b32 a165, 0
    v_accvgpr_write_b32 a166, 0
    v_accvgpr_write_b32 a167, 0
    v_accvgpr_write_b32 a168, 0
    v_accvgpr_write_b32 a169, 0
    v_accvgpr_write_b32 a170, 0
    v_accvgpr_write_b32 a171, 0
    v_accvgpr_write_b32 a172, 0
    v_accvgpr_write_b32 a173, 0
    v_accvgpr_write_b32 a174, 0
    v_accvgpr_write_b32 a175, 0
    v_accvgpr_write_b32 a176, 0
    v_accvgpr_write_b32 a177, 0
    v_accvgpr_write_b32 a178, 0
    v_accvgpr_write_b32 a179, 0
    v_accvgpr_write_b32 a180, 0
    v_accvgpr_write_b32 a181, 0
    v_accvgpr_write_b32 a182, 0
    v_accvgpr_write_b32 a183, 0
    v_accvgpr_write_b32 a184, 0
    v_accvgpr_write_b32 a185, 0
    v_accvgpr_write_b32 a186, 0
    v_accvgpr_write_b32 a187, 0
    v_accvgpr_write_b32 a188, 0
    v_accvgpr_write_b32 a189, 0
    v_accvgpr_write_b32 a190, 0
    v_accvgpr_write_b32 a191, 0
    v_accvgpr_write_b32 a192, 0
    v_accvgpr_write_b32 a193, 0
    v_accvgpr_write_b32 a194, 0
    v_accvgpr_write_b32 a195, 0
    v_accvgpr_write_b32 a196, 0
    v_accvgpr_write_b32 a197, 0
    v_accvgpr_write_b32 a198, 0
    v_accvgpr_write_b32 a199, 0
    v_accvgpr_write_b32 a200, 0
    v_accvgpr_write_b32 a201, 0
    v_accvgpr_write_b32 a202, 0
    v_accvgpr_write_b32 a203, 0
    v_accvgpr_write_b32 a204, 0
    v_accvgpr_write_b32 a205, 0
    v_accvgpr_write_b32 a206, 0
    v_accvgpr_write_b32 a207, 0
    v_accvgpr_write_b32 a208, 0
    v_accvgpr_write_b32 a209, 0
    v_accvgpr_write_b32 a210, 0
    v_accvgpr_write_b32 a211, 0
    v_accvgpr_write_b32 a212, 0
    v_accvgpr_write_b32 a213, 0
    v_accvgpr_write_b32 a214, 0
    v_accvgpr_write_b32 a215, 0
    v_accvgpr_write_b32 a216, 0
    v_accvgpr_write_b32 a217, 0
    v_accvgpr_write_b32 a218, 0
    v_accvgpr_write_b32 a219, 0
    v_accvgpr_write_b32 a220, 0
    v_accvgpr_write_b32 a221, 0
    v_accvgpr_write_b32 a222, 0
    v_accvgpr_write_b32 a223, 0
    s_branch L_spec_ret
L_sp3:
    s_cmp_lg_u32 s28, 0
    s_cbranch_scc1 L_sp3b
    s_lshl_b32 s35, s92, 7
    v_lshlrev_b32 v33, 2, v32
    v_mov_b32 v34, 0
    s_mov_b64 exec, 0xff
    buffer_store_dword v34, v33, s[96:99], s35 offen sc1
    s_mov_b64 exec, -1
L_sp3b:
    s_sub_u32 s39, s39, 4718592
    s_branch L_spec_ret
L_sp14:
    v_mov_b32 v26, v15
    v_mov_b32 v15, 0
    v_mov_b32 v27, v16
    v_mov_b32 v16, 0
    v_add_u32 v32, 131072, v1
    ds_read_b128 a[0:3], v32 offset:0
    ds_read_b128 a[4:7], v32 offset:1024
    ds_read_b128 a[8:11], v32 offset:2048
    ds_read_b128 a[12:15], v32 offset:3072
    ds_read_b128 a[16:19], v32 offset:8192
    ds_read_b128 a[20:23], v32 offset:9216
    ds_read_b128 a[24:27], v32 offset:10240
    ds_read_b128 a[28:31], v32 offset:11264
    ds_read_b128 a[32:35], v32 offset:16384
    ds_read_b128 a[36:39], v32 offset:17408
    ds_read_b128 a[40:43], v32 offset:18432
    ds_read_b128 a[44:47], v32 offset:19456
    ds_read_b128 a[48:51], v32 offset:24576
    ds_read_b128 a[52:55], v32 offset:25600
    ds_read_b128 a[56:59], v32 offset:26624
    ds_read_b128 a[60:63], v32 offset:27648
    s_waitcnt lgkmcnt(0)
    s_barrier
    s_branch L_spec_ret
L_sp20:
    s_cmp_lg_u32 s28, 2
    s_cbranch_scc1 L_spec_ret
    s_mov_b32 s80, s88
    s_mov_b32 s81, s89
    s_mov_b32 s82, 1179648
    s_mov_b32 s83, 0x20000
    v_mul_u32_u24 v33, 36864, v32
    s_mul_i32 s35, s93, 36864
    s_mov_b64 exec, 0xff
    buffer_load_dword v30, v33, s[24:27], 0 offen nt
    s_mov_b64 exec, 1
    buffer_load_dword v30, v33, s[80:83], s35 offen nt
    s_mov_b32 s80, s90
    s_mov_b32 s81, s91
    s_mov_b32 s82, 256
    buffer_load_dword v30, v33, s[80:83], 0 offen nt
    s_mov_b64 exec, -1
    s_branch L_spec_ret
L_sp26:
    s_mov_b32 m0, s38
    s_add_u32 s35, s54, 0
    buffer_load_dwordx4 v9, s[16:19], s35 offen offset:0  lds
    s_add_u32 s35, s54, 8192
    buffer_load_dwordx4 v9, s[16:19], s35 offen offset:1024  lds
    s_add_u32 s35, s54, 16384
    buffer_load_dwordx4 v9, s[16:19], s35 offen offset:2048  lds
    s_add_u32 s35, s54, 24576
    buffer_load_dwordx4 v9, s[16:19], s35 offen offset:3072  lds
    s_add_u32 m0, s38, 4096
    s_add_u32 s35, s54, 36864
    buffer_load_dwordx4 v9, s[16:19], s35 offen offset:0  lds
    s_add_u32 s35, s54, 45056
    buffer_load_dwordx4 v9, s[16:19], s35 offen offset:1024  lds
    s_add_u32 s35, s54, 53248
    buffer_load_dwordx4 v9, s[16:19], s35 offen offset:2048  lds
    s_add_u32 s35, s54, 61440
    buffer_load_dwordx4 v9, s[16:19], s35 offen offset:3072  lds
    s_add_u32 s54, s54, 294912
    s_branch L_spec_ret
L_sp27:
    s_lshr_b32 s35, s28, 1
    s_lshl_b32 s35, s35, 7
    s_add_u32 s74, s41, s35
    s_xor_b32 s41, s74, 128
    s_mov_b32 m0, s49
    s_add_u32 s35, s41, 0
    buffer_load_dwordx4 v9, s[16:19], s35 offen offset:0  lds
    s_add_u32 s35, s41, 8192
    buffer_load_dwordx4 v9, s[16:19], s35 offen offset:1024  lds
    s_add_u32 s35, s41, 16384
    buffer_load_dwordx4 v9, s[16:19], s35 offen offset:2048  lds
    s_add_u32 s35, s41, 24576
    buffer_load_dwordx4 v9, s[16:19], s35 offen offset:3072  lds
    s_add_u32 m0, s49, 4096
    s_add_u32 s35, s41, 36864
    buffer_load_dwordx4 v9, s[16:19], s35 offen offset:0  lds
    s_add_u32 s35, s41, 45056
    buffer_load_dwordx4 v9, s[16:19], s35 offen offset:1024  lds
    s_add_u32 s35, s41, 53248
    buffer_load_dwordx4 v9, s[16:19], s35 offen offset:2048  lds
    s_add_u32 s35, s41, 61440
    buffer_load_dwordx4 v9, s[16:19], s35 offen offset:3072  lds
    s_add_u32 s41, s41, 73728
    s_branch L_spec_ret
L_sp28:
    s_mov_b32 s4, s8
    s_mov_b32 s5, s9
    s_mov_b32 s6, s10
    v_mov_b32 v2, v6
    v_mov_b32 v3, v6
    v_mov_b32 v4, v6
    v_mov_b32 v5, v6
    s_add_u32 s33, s34, 32768
    s_lshl_b32 s35, s28, 5
    s_and_b32 s36, s28, 1
    s_lshl_b32 s36, s36, 6
    s_xor_b32 s35, s35, s36
    v_xor_b32 v10, s35, v13
    v_add_u32 v10, s31, v10
    v_xor_b32 v7, 64, v10
    s_branch L_spec_ret
L_sp29:
    s_mov_b32 s4, s16
    s_mov_b32 s8, s16
    s_mov_b32 s5, s17
    s_mov_b32 s9, s17
    s_mov_b32 s6, s18
    s_mov_b32 s10, s18
    v_add_u32 v2, 0, v9
    v_add_u32 v6, 0, v9
    v_add_u32 v3, 8192, v9
    v_add_u32 v14, 8192, v9
    v_add_u32 v4, 16384, v9
    v_add_u32 v17, 16384, v9
    v_add_u32 v5, 24576, v9
    v_add_u32 v25, 24576, v9
    s_mov_b32 s86, 36864
    s_mov_b32 s87, 147456
    s_mov_b32 s40, 36864
    s_mov_b32 s59, 147456
    s_mov_b32 s34, s74
    s_add_u32 s33, s74, 73728
    s_mov_b32 s95, 64
    s_mov_b32 s72, 0
    s_branch L_spec_ret
L_sp30:
    v_mov_b32 v26, v15
    v_mov_b32 v27, v16
    s_sub_u32 s35, s49, s31
    v_add_u32 v34, s35, v10
    v_add_u32 v35, s35, v7
    v_add_u32 v32, s38, v13
    v_xor_b32 v33, 64, v32
    ds_read_b64_tr_b16 a[0:1], v32 offset:0
    ds_read_b64_tr_b16 a[2:3], v32 offset:512
    ds_read_b64_tr_b16 a[4:5], v33 offset:0
    ds_read_b64_tr_b16 a[6:7], v33 offset:512
    ds_read_b64_tr_b16 a[8:9], v32 offset:2048
    ds_read_b64_tr_b16 a[10:11], v32 offset:2560
    ds_read_b64_tr_b16 a[12:13], v33 offset:2048
    ds_read_b64_tr_b16 a[14:15], v33 offset:2560
    ds_read_b64_tr_b16 a[16:17], v32 offset:4096
    ds_read_b64_tr_b16 a[18:19], v32 offset:4608
    ds_read_b64_tr_b16 a[20:21], v33 offset:4096
    ds_read_b64_tr_b16 a[22:23], v33 offset:4608
    ds_read_b64_tr_b16 a[24:25], v32 offset:6144
    ds_read_b64_tr_b16 a[26:27], v32 offset:6656
    ds_read_b64_tr_b16 a[28:29], v33 offset:6144
    ds_read_b64_tr_b16 a[30:31], v33 offset:6656
    ds_read_b64_tr_b16 a[32:33], v34 offset:0
    ds_read_b64_tr_b16 a[34:35], v34 offset:512
    ds_read_b64_tr_b16 a[36:37], v35 offset:0
    ds_read_b64_tr_b16 a[38:39], v35 offset:512
    ds_read_b64_tr_b16 a[40:41], v34 offset:2048
    ds_read_b64_tr_b16 a[42:43], v34 offset:2560
    ds_read_b64_tr_b16 a[44:45], v35 offset:2048
    ds_read_b64_tr_b16 a[46:47], v35 offset:2560
    ds_read_b64_tr_b16 a[48:49], v34 offset:4096
    ds_read_b64_tr_b16 a[50:51], v34 offset:4608
    ds_read_b64_tr_b16 a[52:53], v35 offset:4096
    ds_read_b64_tr_b16 a[54:55], v35 offset:4608
    ds_read_b64_tr_b16 a[56:57], v34 offset:6144
    ds_read_b64_tr_b16 a[58:59], v34 offset:6656
    ds_read_b64_tr_b16 a[60:61], v35 offset:6144
    ds_read_b64_tr_b16 a[62:63], v35 offset:6656
    s_mov_b32 s30, s48
    s_mov_b32 s48, s38
    s_mov_b32 s72, 0
    s_branch L_spec_ret
L_rare:
    v_max3_f32 v28, v80, v81, v82
    v_max3_f32 v29, v96, v97, v98
    v_max3_f32 v28, v28, v83, v84
    v_max3_f32 v29, v29, v99, v100
    v_max3_f32 v28, v28, v85, v86
    v_max3_f32 v29, v29, v101, v102
    v_max3_f32 v28, v28, v87, v88
    v_max3_f32 v29, v29, v103, v104
    v_max3_f32 v28, v28, v89, v90
    v_max3_f32 v29, v29, v105, v106
    v_max3_f32 v28, v28, v91, v92
    v_max3_f32 v29, v29, v107, v108
    v_max3_f32 v28, v28, v93, v94
    v_max3_f32 v29, v29, v109, v110
    v_max_f32 v28, v28, v95
    v_max_f32 v29, v29, v111
    s_nop 1
    v_permlane32_swap_b32 v28, v29
    v_max_f32 v28, v28, v29
    s_cmp_lg_u32 s57, 0
    s_cbranch_scc1 L_r1
    v_max_f32 v28, 0, v28
L_r1:
    v_mov_b32 v29, v28
    s_nop 1
    v_permlane32_swap_b32 v28, v29
    v_add_f32 v15, v15, v28
    v_add_f32 v16, v16, v29
    v_sub_f32 v80, v80, v28
    v_sub_f32 v96, v96, v29
    v_sub_f32 v81, v81, v28
    v_sub_f32 v97, v97, v29
    v_sub_f32 v82, v82, v28
    v_sub_f32 v98, v98, v29
    v_sub_f32 v83, v83, v28
    v_sub_f32 v99, v99, v29
    v_sub_f32 v84, v84, v28
    v_sub_f32 v100, v100, v29
    v_sub_f32 v85, v85, v28
    v_sub_f32 v101, v101, v29
    v_sub_f32 v86, v86, v28
    v_sub_f32 v102, v102, v29
    v_sub_f32 v87, v87, v28
    v_sub_f32 v103, v103, v29
    v_sub_f32 v88, v88, v28
    v_sub_f32 v104, v104, v29
    v_sub_f32 v89, v89, v28
    v_sub_f32 v105, v105, v29
    v_sub_f32 v90, v90, v28
    v_sub_f32 v106, v106, v29
    v_sub_f32 v91, v91, v28
    v_sub_f32 v107, v107, v29
    v_sub_f32 v92, v92, v28
    v_sub_f32 v108, v108, v29
    v_sub_f32 v93, v93, v28
    v_sub_f32 v109, v109, v29
    v_sub_f32 v94, v94, v28
    v_sub_f32 v110, v110, v29
    v_sub_f32 v95, v95, v28
    v_sub_f32 v111, v111, v29
    s_cbranch_scc1 L_r2
    v_exp_f32 v22, -v28
    v_exp_f32 v24, -v29
    s_nop 0
    v_pk_mul_f32 v[18:19], v[18:19], v[22:23] op_sel_hi:[1,0]
    v_pk_mul_f32 v[20:21], v[20:21], v[24:25] op_sel_hi:[1,0]
    v_pk_mul_f32 v[128:129], v[128:129], v[22:23] op_sel_hi:[1,0]
    v_pk_mul_f32 v[130:131], v[130:131], v[22:23] op_sel_hi:[1,0]
    v_pk_mul_f32 v[132:133], v[132:133], v[22:23] op_sel_hi:[1,0]
    v_pk_mul_f32 v[134:135], v[134:135], v[22:23] op_sel_hi:[1,0]
    v_pk_mul_f32 v[136:137], v[136:137], v[22:23] op_sel_hi:[1,0]
    v_pk_mul_f32 v[138:139], v[138:139], v[22:23] op_sel_hi:[1,0]
    v_pk_mul_f32 v[140:141], v[140:141], v[22:23] op_sel_hi:[1,0]
    v_pk_mul_f32 v[142:143], v[142:143], v[22:23] op_sel_hi:[1,0]
    v_pk_mul_f32 v[144:145], v[144:145], v[24:25] op_sel_hi:[1,0]
    v_pk_mul_f32 v[146:147], v[146:147], v[24:25] op_sel_hi:[1,0]
    v_pk_mul_f32 v[148:149], v[148:149], v[24:25] op_sel_hi:[1,0]
    v_pk_mul_f32 v[150:151], v[150:151], v[24:25] op_sel_hi:[1,0]
    v_pk_mul_f32 v[152:153], v[152:153], v[24:25] op_sel_hi:[1,0]
    v_pk_mul_f32 v[154:155], v[154:155], v[24:25] op_sel_hi:[1,0]
    v_pk_mul_f32 v[156:157], v[156:157], v[24:25] op_sel_hi:[1,0]
    v_pk_mul_f32 v[158:159], v[158:159], v[24:25] op_sel_hi:[1,0]
    v_pk_mul_f32 v[160:161], v[160:161], v[22:23] op_sel_hi:[1,0]
    v_pk_mul_f32 v[162:163], v[162:163], v[22:23] op_sel_hi:[1,0]
    v_pk_mul_f32 v[164:165], v[164:165], v[22:23] op_sel_hi:[1,0]
    v_pk_mul_f32 v[166:167], v[166:167], v[22:23] op_sel_hi:[1,0]
    v_pk_mul_f32 v[168:169], v[168:169], v[22:23] op_sel_hi:[1,0]
    v_pk_mul_f32 v[170:171], v[170:171], v[22:23] op_sel_hi:[1,0]
    v_pk_mul_f32 v[172:173], v[172:173], v[22:23] op_sel_hi:[1,0]
    v_pk_mul_f32 v[174:175], v[174:175], v[22:23] op_sel_hi:[1,0]
    v_pk_mul_f32 v[176:177], v[176:177], v[24:25] op_sel_hi:[1,0]
    v_pk_mul_f32 v[178:179], v[178:179], v[24:25] op_sel_hi:[1,0]
    v_pk_mul_f32 v[180:181], v[180:181], v[24:25] op_sel_hi:[1,0]
    v_pk_mul_f32 v[182:183], v[182:183], v[24:25] op_sel_hi:[1,0]
    v_pk_mul_f32 v[184:185], v[184:185], v[24:25] op_sel_hi:[1,0]
    v_pk_mul_f32 v[186:187], v[186:187], v[24:25] op_sel_hi:[1,0]
    v_pk_mul_f32 v[188:189], v[188:189], v[24:25] op_sel_hi:[1,0]
    v_pk_mul_f32 v[190:191], v[190:191], v[24:25] op_sel_hi:[1,0]
    v_pk_mul_f32 v[192:193], v[192:193], v[22:23] op_sel_hi:[1,0]
    v_pk_mul_f32 v[194:195], v[194:195], v[22:23] op_sel_hi:[1,0]
    v_pk_mul_f32 v[196:197], v[196:197], v[22:23] op_sel_hi:[1,0]
    v_pk_mul_f32 v[198:199], v[198:199], v[22:23] op_sel_hi:[1,0]
    v_pk_mul_f32 v[200:201], v[200:201], v[22:23] op_sel_hi:[1,0]
    v_pk_mul_f32 v[202:203], v[202:203], v[22:23] op_sel_hi:[1,0]
    v_pk_mul_f32 v[204:205], v[204:205], v[22:23] op_sel_hi:[1,0]
    v_pk_mul_f32 v[206:207], v[206:207], v[22:23] op_sel_hi:[1,0]
    v_pk_mul_f32 v[208:209], v[208:209], v[24:25] op_sel_hi:[1,0]
    v_pk_mul_f32 v[210:211], v[210:211], v[24:25] op_sel_hi:[1,0]
    v_pk_mul_f32 v[212:213], v[212:213], v[24:25] op_sel_hi:[1,0]
    v_pk_mul_f32 v[214:215], v[214:215], v[24:25] op_sel_hi:[1,0]
    v_pk_mul_f32 v[216:217], v[216:217], v[24:25] op_sel_hi:[1,0]
    v_pk_mul_f32 v[218:219], v[218:219], v[24:25] op_sel_hi:[1,0]
    v_pk_mul_f32 v[220:221], v[220:221], v[24:25] op_sel_hi:[1,0]
    v_pk_mul_f32 v[222:223], v[222:223], v[24:25] op_sel_hi:[1,0]
    v_pk_mul_f32 v[224:225], v[224:225], v[22:23] op_sel_hi:[1,0]
    v_pk_mul_f32 v[226:227], v[226:227], v[22:23] op_sel_hi:[1,0]
    v_pk_mul_f32 v[228:229], v[228:229], v[22:23] op_sel_hi:[1,0]
    v_pk_mul_f32 v[230:231], v[230:231], v[22:23] op_sel_hi:[1,0]
    v_pk_mul_f32 v[232:233], v[232:233], v[22:23] op_sel_hi:[1,0]
    v_pk_mul_f32 v[234:235], v[234:235], v[22:23] op_sel_hi:[1,0]
    v_pk_mul_f32 v[236:237], v[236:237], v[22:23] op_sel_hi:[1,0]
    v_pk_mul_f32 v[238:239], v[238:239], v[22:23] op_sel_hi:[1,0]
    v_pk_mul_f32 v[240:241], v[240:241], v[24:25] op_sel_hi:[1,0]
    v_pk_mul_f32 v[242:243], v[242:243], v[24:25] op_sel_hi:[1,0]
    v_pk_mul_f32 v[244:245], v[244:245], v[24:25] op_sel_hi:[1,0]
    v_pk_mul_f32 v[246:247], v[246:247], v[24:25] op_sel_hi:[1,0]
    v_pk_mul_f32 v[248:249], v[248:249], v[24:25] op_sel_hi:[1,0]
    v_pk_mul_f32 v[250:251], v[250:251], v[24:25] op_sel_hi:[1,0]
    v_pk_mul_f32 v[252:253], v[252:253], v[24:25] op_sel_hi:[1,0]
    v_pk_mul_f32 v[254:255], v[254:255], v[24:25] op_sel_hi:[1,0]
    s_branch L_rare_ret
L_r2:
    v_pk_mov_b32 v[128:129], 0, 0
    v_pk_mov_b32 v[130:131], 0, 0
    v_pk_mov_b32 v[132:133], 0, 0
    v_pk_mov_b32 v[134:135], 0, 0
    v_pk_mov_b32 v[136:137], 0, 0
    v_pk_mov_b32 v[138:139], 0, 0
    v_pk_mov_b32 v[140:141], 0, 0
    v_pk_mov_b32 v[142:143], 0, 0
    v_pk_mov_b32 v[144:145], 0, 0
    v_pk_mov_b32 v[146:147], 0, 0
    v_pk_mov_b32 v[148:149], 0, 0
    v_pk_mov_b32 v[150:151], 0, 0
    v_pk_mov_b32 v[152:153], 0, 0
    v_pk_mov_b32 v[154:155], 0, 0
    v_pk_mov_b32 v[156:157], 0, 0
    v_pk_mov_b32 v[158:159], 0, 0
    v_pk_mov_b32 v[160:161], 0, 0
    v_pk_mov_b32 v[162:163], 0, 0
    v_pk_mov_b32 v[164:165], 0, 0
    v_pk_mov_b32 v[166:167], 0, 0
    v_pk_mov_b32 v[168:169], 0, 0
    v_pk_mov_b32 v[170:171], 0, 0
    v_pk_mov_b32 v[172:173], 0, 0
    v_pk_mov_b32 v[174:175], 0, 0
    v_pk_mov_b32 v[176:177], 0, 0
    v_pk_mov_b32 v[178:179], 0, 0
    v_pk_mov_b32 v[180:181], 0, 0
    v_pk_mov_b32 v[182:183], 0, 0
    v_pk_mov_b32 v[184:185], 0, 0
    v_pk_mov_b32 v[186:187], 0, 0
    v_pk_mov_b32 v[188:189], 0, 0
    v_pk_mov_b32 v[190:191], 0, 0
    v_pk_mov_b32 v[192:193], 0, 0
    v_pk_mov_b32 v[194:195], 0, 0
    v_pk_mov_b32 v[196:197], 0, 0
    v_pk_mov_b32 v[198:199], 0, 0
    v_pk_mov_b32 v[200:201], 0, 0
    v_pk_mov_b32 v[202:203], 0, 0
    v_pk_mov_b32 v[204:205], 0, 0
    v_pk_mov_b32 v[206:207], 0, 0
    v_pk_mov_b32 v[208:209], 0, 0
    v_pk_mov_b32 v[210:211], 0, 0
    v_pk_mov_b32 v[212:213], 0, 0
    v_pk_mov_b32 v[214:215], 0, 0
    v_pk_mov_b32 v[216:217], 0, 0
    v_pk_mov_b32 v[218:219], 0, 0
    v_pk_mov_b32 v[220:221], 0, 0
    v_pk_mov_b32 v[222:223], 0, 0
    v_pk_mov_b32 v[224:225], 0, 0
    v_pk_mov_b32 v[226:227], 0, 0
    v_pk_mov_b32 v[228:229], 0, 0
    v_pk_mov_b32 v[230:231], 0, 0
    v_pk_mov_b32 v[232:233], 0, 0
    v_pk_mov_b32 v[234:235], 0, 0
    v_pk_mov_b32 v[236:237], 0, 0
    v_pk_mov_b32 v[238:239], 0, 0
    v_pk_mov_b32 v[240:241], 0, 0
    v_pk_mov_b32 v[242:243], 0, 0
    v_pk_mov_b32 v[244:245], 0, 0
    v_pk_mov_b32 v[246:247], 0, 0
    v_pk_mov_b32 v[248:249], 0, 0
    v_pk_mov_b32 v[250:251], 0, 0
    v_pk_mov_b32 v[252:253], 0, 0
    v_pk_mov_b32 v[254:255], 0, 0
    v_pk_mov_b32 v[18:19], 0, 0
    v_pk_mov_b32 v[20:21], 0, 0
    s_mov_b32 s57, 0
    s_branch L_loop
L_combine:
    s_add_u32 s29, s29, 1
    s_waitcnt vmcnt(8)
    s_cmp_eq_u32 s29, 32
    s_cbranch_scc0 L_c0
    ds_read_b64_tr_b16 a[64:65], v10 offset:16384
    ds_read_b64_tr_b16 a[66:67], v10 offset:16896
    ds_read_b64_tr_b16 a[68:69], v7 offset:16384
    ds_read_b64_tr_b16 a[70:71], v7 offset:16896
    ds_read_b64_tr_b16 a[72:73], v10 offset:18432
    ds_read_b64_tr_b16 a[74:75], v10 offset:18944
    ds_read_b64_tr_b16 a[76:77], v7 offset:18432
    ds_read_b64_tr_b16 a[78:79], v7 offset:18944
    ds_read_b64_tr_b16 a[80:81], v10 offset:20480
    ds_read_b64_tr_b16 a[82:83], v10 offset:20992
    ds_read_b64_tr_b16 a[84:85], v7 offset:20480
    ds_read_b64_tr_b16 a[86:87], v7 offset:20992
    ds_read_b64_tr_b16 a[88:89], v10 offset:22528
    ds_read_b64_tr_b16 a[90:91], v10 offset:23040
    ds_read_b64_tr_b16 a[92:93], v7 offset:22528
    ds_read_b64_tr_b16 a[94:95], v7 offset:23040
    ds_read_b64_tr_b16 a[96:97], v10 offset:24576
    ds_read_b64_tr_b16 a[98:99], v10 offset:25088
    ds_read_b64_tr_b16 a[100:101], v7 offset:24576
    ds_read_b64_tr_b16 a[102:103], v7 offset:25088
    ds_read_b64_tr_b16 a[104:105], v10 offset:26624
    ds_read_b64_tr_b16 a[106:107], v10 offset:27136
    ds_read_b64_tr_b16 a[108:109], v7 offset:26624
    ds_read_b64_tr_b16 a[110:111], v7 offset:27136
    ds_read_b64_tr_b16 a[112:113], v10 offset:28672
    ds_read_b64_tr_b16 a[114:115], v10 offset:29184
    ds_read_b64_tr_b16 a[116:117], v7 offset:28672
    ds_read_b64_tr_b16 a[118:119], v7 offset:29184
    ds_read_b64_tr_b16 a[120:121], v10 offset:30720
    ds_read_b64_tr_b16 a[122:123], v10 offset:31232
    ds_read_b64_tr_b16 a[124:125], v7 offset:30720
    ds_read_b64_tr_b16 a[126:127], v7 offset:31232
L_c0:
    v_add_f32 v18, v18, v19
    v_add_f32 v20, v20, v21
    v_add_u32 v32, s38, v1
    v_add_u32 v33, s49, v1
    v_permlane32_swap_b32 v26, v27
    v_permlane32_swap_b32 v18, v20
    v_lshrrev_b32 v34, 1, v1
    v_add_u32 v34, s48, v34
    v_mov_b32 v30, v26
    v_add_f32 v31, v18, v20
    v_add_u32 v35, s51, v1
    v_add_u32 v36, s50, v1
    ds_write_b64 v34, v[30:31]
    ds_write_b128 v33, v[224:227] offset:0
    ds_write_b128 v33, v[228:231] offset:1024
    ds_write_b128 v33, v[232:235] offset:2048
    ds_write_b128 v33, v[236:239] offset:3072
    ds_write_b128 v33, v[240:243] offset:4096
    ds_write_b128 v33, v[244:247] offset:5120
    ds_write_b128 v33, v[248:251] offset:6144
    ds_write_b128 v33, v[252:255] offset:7168
    ds_write_b128 v32, v[160:163] offset:0
    ds_write_b128 v32, v[164:167] offset:1024
    ds_write_b128 v32, v[168:171] offset:2048
    ds_write_b128 v32, v[172:175] offset:3072
    ds_write_b128 v32, v[176:179] offset:4096
    ds_write_b128 v32, v[180:183] offset:5120
    ds_write_b128 v32, v[184:187] offset:6144
    ds_write_b128 v32, v[188:191] offset:7168
    v_xor_b32 v37, 32768, v34
    v_xor_b32 v38, 65536, v34
    v_xor_b32 v39, 98304, v34
    v_xor_b32 v40, 65536, v35
    s_lshl_b32 s35, s28, 11
    s_add_u32 s35, s35, 131072
    v_add_u32 v41, s35, v1
    s_waitcnt lgkmcnt(0)
    s_barrier
    ds_read_b64 v[48:49], v37
    ds_read_b64 v[50:51], v38
    ds_read_b64 v[52:53], v39
    ds_read_b128 v[224:227], v36 offset:0
    ds_read_b128 v[228:231], v36 offset:1024
    ds_read_b128 v[232:235], v36 offset:2048
    ds_read_b128 v[236:239], v36 offset:3072
    ds_read_b128 v[240:243], v36 offset:4096
    ds_read_b128 v[244:247], v36 offset:5120
    ds_read_b128 v[248:251], v36 offset:6144
    ds_read_b128 v[252:255], v36 offset:7168
    ds_read_b128 v[160:163], v35 offset:0
    ds_read_b128 v[164:167], v35 offset:1024
    ds_read_b128 v[168:171], v35 offset:2048
    ds_read_b128 v[172:175], v35 offset:3072
    s_waitcnt lgkmcnt(12)
    ds_read_b128 v[176:179], v35 offset:4096
    ds_read_b128 v[180:183], v35 offset:5120
    ds_read_b128 v[184:187], v35 offset:6144
    ds_read_b128 v[188:191], v35 offset:7168
    v_max3_f32 v28, v30, v48, v50
    v_max_f32 v28, v28, v52
    v_sub_f32 v30, v30, v28
    v_sub_f32 v48, v48, v28
    v_sub_f32 v50, v50, v28
    v_sub_f32 v52, v52, v28
    v_exp_f32 v22, v30
    v_exp_f32 v18, v48
    v_exp_f32 v50, v50
    v_exp_f32 v52, v52
    v_mul_f32 v31, v31, v22
    v_fmac_f32 v31, v49, v18
    v_fmac_f32 v31, v51, v50
    v_fmac_f32 v31, v53, v52
    v_rcp_f32 v29, v31
    s_nop 0
    v_mul_f32 v22, v22, v29
    v_mul_f32 v18, v18, v29
    v_mov_b32 v24, v22
    v_mov_b32 v20, v18
    s_nop 1
    v_permlane32_swap_b32 v22, v24
    v_permlane32_swap_b32 v18, v20
    v_pk_mul_f32 v[192:193], v[192:193], v[22:23] op_sel_hi:[1,0]
    v_pk_mul_f32 v[194:195], v[194:195], v[22:23] op_sel_hi:[1,0]
    v_pk_mul_f32 v[196:197], v[196:197], v[22:23] op_sel_hi:[1,0]
    v_pk_mul_f32 v[198:199], v[198:199], v[22:23] op_sel_hi:[1,0]
    v_pk_mul_f32 v[200:201], v[200:201], v[22:23] op_sel_hi:[1,0]
    v_pk_mul_f32 v[202:203], v[202:203], v[22:23] op_sel_hi:[1,0]
    v_pk_mul_f32 v[204:205], v[204:205], v[22:23] op_sel_hi:[1,0]
    v_pk_mul_f32 v[206:207], v[206:207], v[22:23] op_sel_hi:[1,0]
    v_pk_mul_f32 v[208:209], v[208:209], v[24:25] op_sel_hi:[1,0]
    v_pk_mul_f32 v[210:211], v[210:211], v[24:25] op_sel_hi:[1,0]
    v_pk_mul_f32 v[212:213], v[212:213], v[24:25] op_sel_hi:[1,0]
    v_pk_mul_f32 v[214:215], v[214:215], v[24:25] op_sel_hi:[1,0]
    v_pk_mul_f32 v[216:217], v[216:217], v[24:25] op_sel_hi:[1,0]
    v_pk_mul_f32 v[218:219], v[218:219], v[24:25] op_sel_hi:[1,0]
    v_pk_mul_f32 v[220:221], v[220:221], v[24:25] op_sel_hi:[1,0]
    v_pk_mul_f32 v[222:223], v[222:223], v[24:25] op_sel_hi:[1,0]
    s_waitcnt lgkmcnt(0)
    v_pk_fma_f32 v[192:193], v[224:225], v[18:19], v[192:193] op_sel_hi:[1,0,1]
    v_pk_fma_f32 v[194:195], v[226:227], v[18:19], v[194:195] op_sel_hi:[1,0,1]
    ds_write_b128 v35, v[192:195] offset:0
    v_pk_fma_f32 v[196:197], v[228:229], v[18:19], v[196:197] op_sel_hi:[1,0,1]
    v_pk_fma_f32 v[198:199], v[230:231], v[18:19], v[198:199] op_sel_hi:[1,0,1]
    ds_write_b128 v35, v[196:199] offset:1024
    v_pk_fma_f32 v[200:201], v[232:233], v[18:19], v[200:201] op_sel_hi:[1,0,1]
    v_pk_fma_f32 v[202:203], v[234:235], v[18:19], v[202:203] op_sel_hi:[1,0,1]
    ds_write_b128 v35, v[200:203] offset:2048
    v_pk_fma_f32 v[204:205], v[236:237], v[18:19], v[204:205] op_sel_hi:[1,0,1]
    v_pk_fma_f32 v[206:207], v[238:239], v[18:19], v[206:207] op_sel_hi:[1,0,1]
    ds_write_b128 v35, v[204:207] offset:3072
    v_pk_fma_f32 v[208:209], v[240:241], v[20:21], v[208:209] op_sel_hi:[1,0,1]
    v_pk_fma_f32 v[210:211], v[242:243], v[20:21], v[210:211] op_sel_hi:[1,0,1]
    ds_write_b128 v35, v[208:211] offset:4096
    v_pk_fma_f32 v[212:213], v[244:245], v[20:21], v[212:213] op_sel_hi:[1,0,1]
    v_pk_fma_f32 v[214:215], v[246:247], v[20:21], v[214:215] op_sel_hi:[1,0,1]
    ds_write_b128 v35, v[212:215] offset:5120
    v_pk_fma_f32 v[216:217], v[248:249], v[20:21], v[216:217] op_sel_hi:[1,0,1]
    v_pk_fma_f32 v[218:219], v[250:251], v[20:21], v[218:219] op_sel_hi:[1,0,1]
    ds_write_b128 v35, v[216:219] offset:6144
    v_pk_fma_f32 v[220:221], v[252:253], v[20:21], v[220:221] op_sel_hi:[1,0,1]
    v_pk_fma_f32 v[222:223], v[254:255], v[20:21], v[222:223] op_sel_hi:[1,0,1]
    ds_write_b128 v35, v[220:223] offset:7168
    s_cmp_eq_u32 s29, 32
    s_cbranch_scc0 L_c2
    ds_read_b64_tr_b16 v[80:81], v10 offset:0
    ds_read_b64_tr_b16 v[82:83], v10 offset:512
    ds_read_b64_tr_b16 v[84:85], v7 offset:0
    ds_read_b64_tr_b16 v[86:87], v7 offset:512
    ds_read_b64_tr_b16 v[88:89], v10 offset:2048
    ds_read_b64_tr_b16 v[90:91], v10 offset:2560
    ds_read_b64_tr_b16 v[92:93], v7 offset:2048
    ds_read_b64_tr_b16 v[94:95], v7 offset:2560
    ds_read_b64_tr_b16 v[96:97], v10 offset:4096
    ds_read_b64_tr_b16 v[98:99], v10 offset:4608
    ds_read_b64_tr_b16 v[100:101], v7 offset:4096
    ds_read_b64_tr_b16 v[102:103], v7 offset:4608
    ds_read_b64_tr_b16 v[104:105], v10 offset:6144
    ds_read_b64_tr_b16 v[106:107], v10 offset:6656
    ds_read_b64_tr_b16 v[108:109], v7 offset:6144
    ds_read_b64_tr_b16 v[110:111], v7 offset:6656
L_c2:
    s_waitcnt lgkmcnt(0)
    s_barrier
    ds_read_b128 v[224:227], v40 offset:0
    ds_read_b128 v[228:231], v40 offset:1024
    ds_read_b128 v[232:235], v40 offset:2048
    ds_read_b128 v[236:239], v40 offset:3072
    ds_read_b128 v[240:243], v40 offset:4096
    ds_read_b128 v[244:247], v40 offset:5120
    ds_read_b128 v[248:251], v40 offset:6144
    ds_read_b128 v[252:255], v40 offset:7168
    v_pk_mul_f32 v[128:129], v[128:129], v[22:23] op_sel_hi:[1,0]
    v_pk_mul_f32 v[130:131], v[130:131], v[22:23] op_sel_hi:[1,0]
    v_pk_mul_f32 v[132:133], v[132:133], v[22:23] op_sel_hi:[1,0]
    v_pk_mul_f32 v[134:135], v[134:135], v[22:23] op_sel_hi:[1,0]
    v_pk_mul_f32 v[136:137], v[136:137], v[22:23] op_sel_hi:[1,0]
    v_pk_mul_f32 v[138:139], v[138:139], v[22:23] op_sel_hi:[1,0]
    v_pk_mul_f32 v[140:141], v[140:141], v[22:23] op_sel_hi:[1,0]
    v_pk_mul_f32 v[142:143], v[142:143], v[22:23] op_sel_hi:[1,0]
    v_pk_mul_f32 v[144:145], v[144:145], v[24:25] op_sel_hi:[1,0]
    v_pk_mul_f32 v[146:147], v[146:147], v[24:25] op_sel_hi:[1,0]
    v_pk_mul_f32 v[148:149], v[148:149], v[24:25] op_sel_hi:[1,0]
    v_pk_mul_f32 v[150:151], v[150:151], v[24:25] op_sel_hi:[1,0]
    v_pk_mul_f32 v[152:153], v[152:153], v[24:25] op_sel_hi:[1,0]
    v_pk_mul_f32 v[154:155], v[154:155], v[24:25] op_sel_hi:[1,0]
    v_pk_mul_f32 v[156:157], v[156:157], v[24:25] op_sel_hi:[1,0]
    v_pk_mul_f32 v[158:159], v[158:159], v[24:25] op_sel_hi:[1,0]
    v_pk_fma_f32 v[128:129], v[160:161], v[18:19], v[128:129] op_sel_hi:[1,0,1]
    v_pk_fma_f32 v[130:131], v[162:163], v[18:19], v[130:131] op_sel_hi:[1,0,1]
    v_pk_fma_f32 v[132:133], v[164:165], v[18:19], v[132:133] op_sel_hi:[1,0,1]
    v_pk_fma_f32 v[134:135], v[166:167], v[18:19], v[134:135] op_sel_hi:[1,0,1]
    v_pk_fma_f32 v[136:137], v[168:169], v[18:19], v[136:137] op_sel_hi:[1,0,1]
    v_pk_fma_f32 v[138:139], v[170:171], v[18:19], v[138:139] op_sel_hi:[1,0,1]
    v_pk_fma_f32 v[140:141], v[172:173], v[18:19], v[140:141] op_sel_hi:[1,0,1]
    v_pk_fma_f32 v[142:143], v[174:175], v[18:19], v[142:143] op_sel_hi:[1,0,1]
    v_pk_fma_f32 v[144:145], v[176:177], v[20:21], v[144:145] op_sel_hi:[1,0,1]
    v_pk_fma_f32 v[146:147], v[178:179], v[20:21], v[146:147] op_sel_hi:[1,0,1]
    v_pk_fma_f32 v[148:149], v[180:181], v[20:21], v[148:149] op_sel_hi:[1,0,1]
    v_pk_fma_f32 v[150:151], v[182:183], v[20:21], v[150:151] op_sel_hi:[1,0,1]
    v_pk_fma_f32 v[152:153], v[184:185], v[20:21], v[152:153] op_sel_hi:[1,0,1]
    v_pk_fma_f32 v[154:155], v[186:187], v[20:21], v[154:155] op_sel_hi:[1,0,1]
    v_pk_fma_f32 v[156:157], v[188:189], v[20:21], v[156:157] op_sel_hi:[1,0,1]
    v_pk_fma_f32 v[158:159], v[190:191], v[20:21], v[158:159] op_sel_hi:[1,0,1]
    s_waitcnt lgkmcnt(6)
    v_pk_add_f32 v[128:129], v[128:129], v[224:225]
    v_pk_add_f32 v[130:131], v[130:131], v[226:227]
    v_pk_add_f32 v[132:133], v[132:133], v[228:229]
    v_pk_add_f32 v[134:135], v[134:135], v[230:231]
    v_cvt_pk_bf16_f32 v192, v128, v129
    v_cvt_pk_bf16_f32 v193, v130, v131
    v_cvt_pk_bf16_f32 v194, v132, v133
    v_cvt_pk_bf16_f32 v195, v134, v135
    ds_write_b128 v41, v[192:195] offset:0
    s_waitcnt lgkmcnt(5)
    v_pk_add_f32 v[136:137], v[136:137], v[232:233]
    v_pk_add_f32 v[138:139], v[138:139], v[234:235]
    v_pk_add_f32 v[140:141], v[140:141], v[236:237]
    v_pk_add_f32 v[142:143], v[142:143], v[238:239]
    v_cvt_pk_bf16_f32 v196, v136, v137
    v_cvt_pk_bf16_f32 v197, v138, v139
    v_cvt_pk_bf16_f32 v198, v140, v141
    v_cvt_pk_bf16_f32 v199, v142, v143
    ds_write_b128 v41, v[196:199] offset:1024
    s_waitcnt lgkmcnt(4)
    v_pk_add_f32 v[144:145], v[144:145], v[240:241]
    v_pk_add_f32 v[146:147], v[146:147], v[242:243]
    v_pk_add_f32 v[148:149], v[148:149], v[244:245]
    v_pk_add_f32 v[150:151], v[150:151], v[246:247]
    v_cvt_pk_bf16_f32 v200, v144, v145
    v_cvt_pk_bf16_f32 v201, v146, v147
    v_cvt_pk_bf16_f32 v202, v148, v149
    v_cvt_pk_bf16_f32 v203, v150, v151
    ds_write_b128 v41, v[200:203] offset:8192
    s_waitcnt lgkmcnt(3)
    v_pk_add_f32 v[152:153], v[152:153], v[248:249]
    v_pk_add_f32 v[154:155], v[154:155], v[250:251]
    v_pk_add_f32 v[156:157], v[156:157], v[252:253]
    v_pk_add_f32 v[158:159], v[158:159], v[254:255]
    v_cvt_pk_bf16_f32 v204, v152, v153
    v_cvt_pk_bf16_f32 v205, v154, v155
    v_cvt_pk_bf16_f32 v206, v156, v157
    v_cvt_pk_bf16_f32 v207, v158, v159
    ds_write_b128 v41, v[204:207] offset:9216
    s_mov_b32 s47, 0
    s_waitcnt lgkmcnt(0)
    s_barrier
    s_lshl_b32 s35, s28, 12
    s_add_u32 s35, s35, 131072
    v_add_u32 v36, s35, v1
    ds_read_b128 a[224:227], v36 offset:0
    ds_read_b128 a[228:231], v36 offset:1024
    ds_read_b128 a[232:235], v36 offset:2048
    ds_read_b128 a[236:239], v36 offset:3072
    s_cmp_eq_u32 s29, 32
    s_cbranch_scc1 L_tail
    s_mov_b32 m0, s38
    s_add_u32 s35, s54, 0
    buffer_load_dwordx4 v9, s[16:19], s35 offen offset:0  lds
    s_add_u32 s35, s54, 8192
    buffer_load_dwordx4 v9, s[16:19], s35 offen offset:1024  lds
    s_add_u32 s35, s54, 16384
    buffer_load_dwordx4 v9, s[16:19], s35 offen offset:2048  lds
    s_add_u32 s35, s54, 24576
    buffer_load_dwordx4 v9, s[16:19], s35 offen offset:3072  lds
    s_add_u32 m0, s38, 4096
    s_add_u32 s35, s54, 36864
    buffer_load_dwordx4 v9, s[16:19], s35 offen offset:0  lds
    s_add_u32 s35, s54, 45056
    buffer_load_dwordx4 v9, s[16:19], s35 offen offset:1024  lds
    s_add_u32 s35, s54, 53248
    buffer_load_dwordx4 v9, s[16:19], s35 offen offset:2048  lds
    s_add_u32 s35, s54, 61440
    buffer_load_dwordx4 v9, s[16:19], s35 offen offset:3072  lds
    s_add_u32 s54, s54, 294912
    s_lshl_b32 s35, s28, 5
    v_xor_b32 v13, s35, v13
    v_mov_b32 v31, 0
    s_mov_b32 s57, 2
    s_waitcnt lgkmcnt(0)
    s_branch L_rare
L_tail:
    s_add_u32 s53, s31, 16384
    v_add_u32 v37, 131072, v1
    ds_read_b128 v[192:195], v37 offset:0
    ds_read_b128 v[196:199], v37 offset:1024
    ds_read_b128 v[200:203], v37 offset:2048
    ds_read_b128 v[204:207], v37 offset:3072
    ds_read_b128 v[208:211], v37 offset:4096
    ds_read_b128 v[212:215], v37 offset:5120
    ds_read_b128 v[216:219], v37 offset:6144
    ds_read_b128 v[220:223], v37 offset:7168
    ds_read_b128 v[224:227], v37 offset:8192
    ds_read_b128 v[228:231], v37 offset:9216
    ds_read_b128 v[232:235], v37 offset:10240
    ds_read_b128 v[236:239], v37 offset:11264
    ds_read_b128 v[240:243], v37 offset:12288
    ds_read_b128 v[244:247], v37 offset:13312
    ds_read_b128 v[248:251], v37 offset:14336
    ds_read_b128 v[252:255], v37 offset:15360
    s_mul_i32 s36, s28, 9216
    s_mul_i32 s35, s92, 36864
    s_add_u32 s36, s36, s35
    v_add_u32 v32, s31, v1
    v_xor_b32 v33, 32768, v32
    v_xor_b32 v34, 65536, v32
    v_xor_b32 v35, 98304, v32
    s_waitcnt lgkmcnt(12)
    v_mfma_f32_32x32x16_bf16 a[192:207], a[0:3], a[224:227], a[192:207]
    s_mov_b32 m0, s31
    s_add_u32 s35, s41, 0
    v_mfma_f32_32x32x16_bf16 a[208:223], a[4:7], a[224:227], a[208:223]
    buffer_load_dwordx4 v9, s[16:19], s35 offen offset:0  lds
    v_mfma_f32_32x32x16_bf16 a[192:207], a[8:11], a[228:231], a[192:207]
    s_add_u32 s35, s41, 8192
    v_mfma_f32_32x32x16_bf16 a[208:223], a[12:15], a[228:231], a[208:223]
    buffer_load_dwordx4 v9, s[16:19], s35 offen offset:1024  lds
    v_mfma_f32_32x32x16_bf16 a[192:207], a[16:19], a[232:235], a[192:207]
    s_add_u32 s35, s41, 16384
    v_mfma_f32_32x32x16_bf16 a[208:223], a[20:23], a[232:235], a[208:223]
    buffer_load_dwordx4 v9, s[16:19], s35 offen offset:2048  lds
    v_mfma_f32_32x32x16_bf16 a[192:207], a[24:27], a[236:239], a[192:207]
    s_add_u32 s35, s41, 24576
    v_mfma_f32_32x32x16_bf16 a[208:223], a[28:31], a[236:239], a[208:223]
    buffer_load_dwordx4 v9, s[16:19], s35 offen offset:3072  lds
    s_waitcnt lgkmcnt(0)
    v_mfma_f32_32x32x16_bf16 a[128:143], a[64:67], v[192:195], a[128:143]
    s_add_u32 m0, s31, 4096
    s_add_u32 s35, s41, 36864
    v_mfma_f32_32x32x16_bf16 a[144:159], a[68:71], v[192:195], a[144:159]
    buffer_load_dwordx4 v9, s[16:19], s35 offen offset:0  lds
    v_mfma_f32_32x32x16_bf16 a[128:143], a[72:75], v[196:199], a[128:143]
    s_add_u32 s35, s41, 45056
    v_mfma_f32_32x32x16_bf16 a[144:159], a[76:79], v[196:199], a[144:159]
    buffer_load_dwordx4 v9, s[16:19], s35 offen offset:1024  lds
    v_mfma_f32_32x32x16_bf16 a[128:143], a[80:83], v[200:203], a[128:143]
    s_add_u32 s35, s41, 53248
    v_mfma_f32_32x32x16_bf16 a[144:159], a[84:87], v[200:203], a[144:159]
    buffer_load_dwordx4 v9, s[16:19], s35 offen offset:2048  lds
    s_add_u32 s35, s41, 61440
    v_mfma_f32_32x32x16_bf16 a[128:143], a[88:91], v[204:207], a[128:143]
    buffer_load_dwordx4 v9, s[16:19], s35 offen offset:3072  lds
    v_mfma_f32_32x32x16_bf16 a[144:159], a[92:95], v[204:207], a[144:159]
    s_add_u32 s41, s41, 73728
    s_waitcnt vmcnt(8)
    v_mfma_f32_32x32x16_bf16 a[128:143], a[96:99], v[224:227], a[128:143]
    s_mov_b32 m0, s53
    s_add_u32 s35, s41, 0
    buffer_load_dwordx4 v9, s[16:19], s35 offen offset:0  lds
    v_mfma_f32_32x32x16_bf16 a[144:159], a[100:103], v[224:227], a[144:159]
    ds_read_b64_tr_b16 a[0:1], v10 offset:8192
    ds_read_b64_tr_b16 a[2:3], v10 offset:8704
    ds_read_b64_tr_b16 a[4:5], v7 offset:8192
    ds_read_b64_tr_b16 a[6:7], v7 offset:8704
    v_mfma_f32_32x32x16_bf16 a[128:143], a[104:107], v[228:231], a[128:143]
    s_add_u32 s35, s41, 8192
    buffer_load_dwordx4 v9, s[16:19], s35 offen offset:1024  lds
    v_mfma_f32_32x32x16_bf16 a[144:159], a[108:111], v[228:231], a[144:159]
    ds_read_b64_tr_b16 a[8:9], v10 offset:10240
    ds_read_b64_tr_b16 a[10:11], v10 offset:10752
    ds_read_b64_tr_b16 a[12:13], v7 offset:10240
    ds_read_b64_tr_b16 a[14:15], v7 offset:10752
    v_mfma_f32_32x32x16_bf16 a[128:143], a[112:115], v[232:235], a[128:143]
    s_add_u32 s35, s41, 16384
    buffer_load_dwordx4 v9, s[16:19], s35 offen offset:2048  lds
    v_mfma_f32_32x32x16_bf16 a[144:159], a[116:119], v[232:235], a[144:159]
    ds_read_b64_tr_b16 a[16:17], v10 offset:12288
    ds_read_b64_tr_b16 a[18:19], v10 offset:12800
    ds_read_b64_tr_b16 a[20:21], v7 offset:12288
    ds_read_b64_tr_b16 a[22:23], v7 offset:12800
    v_mfma_f32_32x32x16_bf16 a[128:143], a[120:123], v[236:239], a[128:143]
    s_add_u32 s35, s41, 24576
    buffer_load_dwordx4 v9, s[16:19], s35 offen offset:3072  lds
    ds_read_b64_tr_b16 a[24:25], v10 offset:14336
    v_mfma_f32_32x32x16_bf16 a[144:159], a[124:127], v[236:239], a[144:159]
    ds_read_b64_tr_b16 a[26:27], v10 offset:14848
    ds_read_b64_tr_b16 a[28:29], v7 offset:14336
    ds_read_b64_tr_b16 a[30:31], v7 offset:14848
    v_mfma_f32_32x32x16_bf16 a[128:143], v[80:83], v[208:211], a[128:143]
    s_add_u32 m0, s53, 4096
    s_add_u32 s35, s41, 36864
    buffer_load_dwordx4 v9, s[16:19], s35 offen offset:0  lds
    v_mfma_f32_32x32x16_bf16 a[144:159], v[84:87], v[208:211], a[144:159]
    ds_write_b128 v32, a[200:203] offset:10240
    ds_write_b128 v32, a[204:207] offset:11264
    ds_write_b128 v32, a[208:211] offset:12288
    v_mfma_f32_32x32x16_bf16 a[128:143], v[88:91], v[212:215], a[128:143]
    s_add_u32 s35, s41, 45056
    buffer_load_dwordx4 v9, s[16:19], s35 offen offset:1024  lds
    v_mfma_f32_32x32x16_bf16 a[144:159], v[92:95], v[212:215], a[144:159]
    ds_write_b128 v32, a[212:215] offset:13312
    ds_write_b128 v32, a[216:219] offset:14336
    ds_write_b128 v32, a[220:223] offset:15360
    v_mfma_f32_32x32x16_bf16 a[128:143], v[96:99], v[216:219], a[128:143]
    s_add_u32 s35, s41, 53248
    buffer_load_dwordx4 v9, s[16:19], s35 offen offset:2048  lds
    v_mfma_f32_32x32x16_bf16 a[144:159], v[100:103], v[216:219], a[144:159]
    v_accvgpr_read_b32 v48, a192
    v_accvgpr_read_b32 v49, a193
    v_accvgpr_read_b32 v50, a194
    v_accvgpr_read_b32 v51, a195
    v_mfma_f32_32x32x16_bf16 a[128:143], v[104:107], v[220:223], a[128:143]
    s_add_u32 s35, s41, 61440
    buffer_load_dwordx4 v9, s[16:19], s35 offen offset:3072  lds
    s_add_u32 s41, s41, 73728
    v_mfma_f32_32x32x16_bf16 a[144:159], v[108:111], v[220:223], a[144:159]
    v_accvgpr_read_b32 v52, a196
    v_accvgpr_read_b32 v53, a197
    v_accvgpr_read_b32 v54, a198
    v_accvgpr_read_b32 v55, a199
    s_waitcnt lgkmcnt(0)
    s_barrier
    s_waitcnt vmcnt(8)
    v_mfma_f32_32x32x16_bf16 a[128:143], a[0:3], v[240:243], a[128:143]
    s_mov_b32 m0, s38
    s_add_u32 s35, s41, 0
    buffer_load_dwordx4 v9, s[16:19], s35 offen offset:0  lds
    ds_read_b64_tr_b16 a[64:65], v10 offset:0
    v_mfma_f32_32x32x16_bf16 a[144:159], a[4:7], v[240:243], a[144:159]
    ds_read_b64_tr_b16 a[66:67], v10 offset:512
    ds_read_b64_tr_b16 a[68:69], v7 offset:0
    ds_read_b64_tr_b16 a[70:71], v7 offset:512
    ds_read_b64_tr_b16 a[72:73], v10 offset:2048
    v_mfma_f32_32x32x16_bf16 a[128:143], a[8:11], v[244:247], a[128:143]
    ds_read_b64_tr_b16 a[74:75], v10 offset:2560
    s_add_u32 s35, s41, 8192
    buffer_load_dwordx4 v9, s[16:19], s35 offen offset:1024  lds
    ds_read_b64_tr_b16 a[76:77], v7 offset:2048
    v_mfma_f32_32x32x16_bf16 a[144:159], a[12:15], v[244:247], a[144:159]
    ds_read_b64_tr_b16 a[78:79], v7 offset:2560
    ds_read_b64_tr_b16 a[80:81], v10 offset:4096
    ds_read_b64_tr_b16 a[82:83], v10 offset:4608
    ds_read_b64_tr_b16 a[84:85], v7 offset:4096
    v_mfma_f32_32x32x16_bf16 a[128:143], a[16:19], v[248:251], a[128:143]
    s_add_u32 s35, s41, 16384
    buffer_load_dwordx4 v9, s[16:19], s35 offen offset:2048  lds
    ds_read_b64_tr_b16 a[86:87], v7 offset:4608
    v_mfma_f32_32x32x16_bf16 a[144:159], a[20:23], v[248:251], a[144:159]
    ds_read_b64_tr_b16 a[88:89], v10 offset:6144
    ds_read_b64_tr_b16 a[90:91], v10 offset:6656
    ds_read_b64_tr_b16 a[92:93], v7 offset:6144
    ds_read_b64_tr_b16 a[94:95], v7 offset:6656
    v_mfma_f32_32x32x16_bf16 a[128:143], a[24:27], v[252:255], a[128:143]
    ds_read_b128 v[88:91], v33 offset:10240
    s_add_u32 s35, s41, 24576
    buffer_load_dwordx4 v9, s[16:19], s35 offen offset:3072  lds
    ds_read_b128 v[92:95], v33 offset:11264
    v_mfma_f32_32x32x16_bf16 a[144:159], a[28:31], v[252:255], a[144:159]
    ds_read_b128 v[96:99], v34 offset:12288
    ds_read_b128 v[100:103], v34 offset:13312
    ds_read_b128 v[104:107], v35 offset:14336
    ds_read_b128 v[108:111], v35 offset:15360
    s_waitcnt vmcnt(4)
    v_mfma_f32_32x32x16_bf16 a[160:175], a[32:35], v[192:195], a[160:175]
    s_add_u32 m0, s38, 4096
    s_add_u32 s35, s41, 36864
    buffer_load_dwordx4 v9, s[16:19], s35 offen offset:0  lds
    v_mfma_f32_32x32x16_bf16 a[176:191], a[36:39], v[192:195], a[176:191]
    ds_read_b64_tr_b16 a[96:97], v10 offset:16384
    ds_read_b64_tr_b16 a[98:99], v10 offset:16896
    ds_read_b64_tr_b16 a[100:101], v7 offset:16384
    ds_read_b64_tr_b16 a[102:103], v7 offset:16896
    v_mfma_f32_32x32x16_bf16 a[160:175], a[40:43], v[196:199], a[160:175]
    s_add_u32 s35, s41, 45056
    buffer_load_dwordx4 v9, s[16:19], s35 offen offset:1024  lds
    ds_read_b64_tr_b16 a[104:105], v10 offset:18432
    v_mfma_f32_32x32x16_bf16 a[176:191], a[44:47], v[196:199], a[176:191]
    ds_read_b64_tr_b16 a[106:107], v10 offset:18944
    ds_read_b64_tr_b16 a[108:109], v7 offset:18432
    ds_read_b64_tr_b16 a[110:111], v7 offset:18944
    v_mfma_f32_32x32x16_bf16 a[160:175], a[48:51], v[200:203], a[160:175]
    s_add_u32 s35, s41, 53248
    buffer_load_dwordx4 v9, s[16:19], s35 offen offset:2048  lds
    ds_read_b64_tr_b16 a[112:113], v10 offset:20480
    v_mfma_f32_32x32x16_bf16 a[176:191], a[52:55], v[200:203], a[176:191]
    ds_read_b64_tr_b16 a[114:115], v10 offset:20992
    ds_read_b64_tr_b16 a[116:117], v7 offset:20480
    ds_read_b64_tr_b16 a[118:119], v7 offset:20992
    s_add_u32 s35, s41, 61440
    v_mfma_f32_32x32x16_bf16 a[160:175], a[56:59], v[204:207], a[160:175]
    buffer_load_dwordx4 v9, s[16:19], s35 offen offset:3072  lds
    s_add_u32 s41, s41, 73728
    ds_read_b64_tr_b16 a[120:121], v10 offset:22528
    v_mfma_f32_32x32x16_bf16 a[176:191], a[60:63], v[204:207], a[176:191]
    ds_read_b64_tr_b16 a[122:123], v10 offset:23040
    ds_read_b64_tr_b16 a[124:125], v7 offset:22528
    ds_read_b64_tr_b16 a[126:127], v7 offset:23040
    s_waitcnt lgkmcnt(0)
    v_mfma_f32_32x32x16_bf16 a[160:175], a[64:67], v[208:211], a[160:175]
    s_add_u32 s47, s36, 0
    v_accvgpr_read_b32 v128, a128
    v_accvgpr_read_b32 v129, a129
    v_accvgpr_read_b32 v130, a130
    v_accvgpr_read_b32 v131, a131
    v_accvgpr_read_b32 v132, a132
    v_mfma_f32_32x32x16_bf16 a[176:191], a[68:71], v[208:211], a[176:191]
    v_accvgpr_read_b32 v133, a133
    v_accvgpr_read_b32 v134, a134
    v_accvgpr_read_b32 v135, a135
    v_cvt_pk_bf16_f32 v128, v128, v129
    v_cvt_pk_bf16_f32 v129, v130, v131
    v_mfma_f32_32x32x16_bf16 a[160:175], a[72:75], v[212:215], a[160:175]
    v_cvt_pk_bf16_f32 v130, v132, v133
    v_cvt_pk_bf16_f32 v131, v134, v135
    buffer_store_dwordx4 v[128:131], v1, s[24:27], s47 offen offset:0 sc1
    v_accvgpr_read_b32 v136, a136
    v_mfma_f32_32x32x16_bf16 a[176:191], a[76:79], v[212:215], a[176:191]
    v_accvgpr_read_b32 v137, a137
    v_accvgpr_read_b32 v138, a138
    v_accvgpr_read_b32 v139, a139
    v_accvgpr_read_b32 v140, a140
    v_accvgpr_read_b32 v141, a141
    v_accvgpr_read_b32 v142, a142
    v_mfma_f32_32x32x16_bf16 a[160:175], a[80:83], v[216:219], a[160:175]
    v_accvgpr_read_b32 v143, a143
    v_cvt_pk_bf16_f32 v136, v136, v137
    v_cvt_pk_bf16_f32 v137, v138, v139
    v_cvt_pk_bf16_f32 v138, v140, v141
    v_cvt_pk_bf16_f32 v139, v142, v143
    v_mfma_f32_32x32x16_bf16 a[176:191], a[84:87], v[216:219], a[176:191]
    buffer_store_dwordx4 v[136:139], v1, s[24:27], s47 offen offset:1024 sc1
    v_pk_add_f32 v[48:49], v[48:49], v[88:89]
    v_pk_add_f32 v[50:51], v[50:51], v[90:91]
    v_mfma_f32_32x32x16_bf16 a[160:175], a[88:91], v[220:223], a[160:175]
    v_pk_add_f32 v[52:53], v[52:53], v[92:93]
    v_pk_add_f32 v[54:55], v[54:55], v[94:95]
    v_pk_add_f32 v[48:49], v[48:49], v[96:97]
    v_pk_add_f32 v[50:51], v[50:51], v[98:99]
    v_pk_add_f32 v[52:53], v[52:53], v[100:101]
    v_mfma_f32_32x32x16_bf16 a[176:191], a[92:95], v[220:223], a[176:191]
    v_pk_add_f32 v[54:55], v[54:55], v[102:103]
    v_pk_add_f32 v[48:49], v[48:49], v[104:105]
    v_pk_add_f32 v[50:51], v[50:51], v[106:107]
    v_pk_add_f32 v[52:53], v[52:53], v[108:109]
    v_pk_add_f32 v[54:55], v[54:55], v[110:111]
    s_waitcnt vmcnt(2)
    v_mfma_f32_32x32x16_bf16 a[160:175], a[96:99], v[224:227], a[160:175]
    ds_read_b64_tr_b16 a[0:1], v10 offset:24576
    ds_read_b64_tr_b16 a[2:3], v10 offset:25088
    ds_read_b64_tr_b16 a[4:5], v7 offset:24576
    v_mfma_f32_32x32x16_bf16 a[176:191], a[100:103], v[224:227], a[176:191]
    ds_read_b64_tr_b16 a[6:7], v7 offset:25088
    ds_read_b64_tr_b16 a[8:9], v10 offset:26624
    ds_read_b64_tr_b16 a[10:11], v10 offset:27136
    v_mfma_f32_32x32x16_bf16 a[160:175], a[104:107], v[228:231], a[160:175]
    ds_read_b64_tr_b16 a[12:13], v7 offset:26624
    ds_read_b64_tr_b16 a[14:15], v7 offset:27136
    v_mfma_f32_32x32x16_bf16 a[176:191], a[108:111], v[228:231], a[176:191]
    ds_read_b64_tr_b16 a[16:17], v10 offset:28672
    ds_read_b64_tr_b16 a[18:19], v10 offset:29184
    ds_read_b64_tr_b16 a[20:21], v7 offset:28672
    v_mfma_f32_32x32x16_bf16 a[160:175], a[112:115], v[232:235], a[160:175]
    ds_read_b64_tr_b16 a[22:23], v7 offset:29184
    ds_read_b64_tr_b16 a[24:25], v10 offset:30720
    ds_read_b64_tr_b16 a[26:27], v10 offset:31232
    v_mfma_f32_32x32x16_bf16 a[176:191], a[116:119], v[232:235], a[176:191]
    ds_read_b64_tr_b16 a[28:29], v7 offset:30720
    ds_read_b64_tr_b16 a[30:31], v7 offset:31232
    v_cvt_pk_bf16_f32 v56, v48, v49
    v_mfma_f32_32x32x16_bf16 a[160:175], a[120:123], v[236:239], a[160:175]
    v_cvt_pk_bf16_f32 v57, v50, v51
    v_cvt_pk_bf16_f32 v58, v52, v53
    v_cvt_pk_bf16_f32 v59, v54, v55
    v_mfma_f32_32x32x16_bf16 a[176:191], a[124:127], v[236:239], a[176:191]
    s_add_u32 s35, s36, 8192
    buffer_store_dwordx4 v[56:59], v1, s[24:27], s35 offen sc1
    s_waitcnt lgkmcnt(0)
    v_mfma_f32_32x32x16_bf16 a[160:175], a[0:3], v[240:243], a[160:175]
    v_accvgpr_read_b32 v144, a144
    v_accvgpr_read_b32 v145, a145
    v_accvgpr_read_b32 v146, a146
    v_accvgpr_read_b32 v147, a147
    v_mfma_f32_32x32x16_bf16 a[160:175], a[8:11], v[244:247], a[160:175]
    v_accvgpr_read_b32 v148, a148
    v_accvgpr_read_b32 v149, a149
    v_accvgpr_read_b32 v150, a150
    v_accvgpr_read_b32 v151, a151
    v_mfma_f32_32x32x16_bf16 a[160:175], a[16:19], v[248:251], a[160:175]
    v_cvt_pk_bf16_f32 v144, v144, v145
    v_cvt_pk_bf16_f32 v145, v146, v147
    v_cvt_pk_bf16_f32 v146, v148, v149
    v_mfma_f32_32x32x16_bf16 a[160:175], a[24:27], v[252:255], a[160:175]
    v_cvt_pk_bf16_f32 v147, v150, v151
    buffer_store_dwordx4 v[144:147], v1, s[24:27], s47 offen offset:2048 sc1
    v_mfma_f32_32x32x16_bf16 a[176:191], a[4:7], v[240:243], a[176:191]
    v_accvgpr_read_b32 v152, a152
    v_accvgpr_read_b32 v153, a153
    v_accvgpr_read_b32 v154, a154
    v_accvgpr_read_b32 v155, a155
    v_mfma_f32_32x32x16_bf16 a[176:191], a[12:15], v[244:247], a[176:191]
    v_accvgpr_read_b32 v156, a156
    v_accvgpr_read_b32 v157, a157
    v_accvgpr_read_b32 v158, a158
    v_accvgpr_read_b32 v159, a159
    v_mfma_f32_32x32x16_bf16 a[176:191], a[20:23], v[248:251], a[176:191]
    v_cvt_pk_bf16_f32 v152, v152, v153
    v_cvt_pk_bf16_f32 v153, v154, v155
    v_cvt_pk_bf16_f32 v154, v156, v157
    v_mfma_f32_32x32x16_bf16 a[176:191], a[28:31], v[252:255], a[176:191]
    v_cvt_pk_bf16_f32 v155, v158, v159
    buffer_store_dwordx4 v[152:155], v1, s[24:27], s47 offen offset:3072 sc1
    s_add_u32 s47, s36, 4096
    v_accvgpr_read_b32 v160, a160
    v_accvgpr_read_b32 v161, a161
    v_accvgpr_read_b32 v162, a162
    v_accvgpr_read_b32 v163, a163
    v_accvgpr_read_b32 v164, a164
    v_accvgpr_read_b32 v165, a165
    v_accvgpr_read_b32 v166, a166
    v_accvgpr_read_b32 v167, a167
    v_cvt_pk_bf16_f32 v160, v160, v161
    v_cvt_pk_bf16_f32 v161, v162, v163
    v_cvt_pk_bf16_f32 v162, v164, v165
    v_cvt_pk_bf16_f32 v163, v166, v167
    buffer_store_dwordx4 v[160:163], v1, s[24:27], s47 offen offset:0 sc1
    v_accvgpr_read_b32 v168, a168
    v_accvgpr_read_b32 v169, a169
    v_accvgpr_read_b32 v170, a170
    v_accvgpr_read_b32 v171, a171
    v_accvgpr_read_b32 v172, a172
    v_accvgpr_read_b32 v173, a173
    v_accvgpr_read_b32 v174, a174
    v_accvgpr_read_b32 v175, a175
    v_cvt_pk_bf16_f32 v168, v168, v169
    v_cvt_pk_bf16_f32 v169, v170, v171
    v_cvt_pk_bf16_f32 v170, v172, v173
    v_cvt_pk_bf16_f32 v171, v174, v175
    buffer_store_dwordx4 v[168:171], v1, s[24:27], s47 offen offset:1024 sc1
    v_accvgpr_read_b32 v176, a176
    v_accvgpr_read_b32 v177, a177
    v_accvgpr_read_b32 v178, a178
    v_accvgpr_read_b32 v179, a179
    v_accvgpr_read_b32 v180, a180
    v_accvgpr_read_b32 v181, a181
    v_accvgpr_read_b32 v182, a182
    v_accvgpr_read_b32 v183, a183
    v_cvt_pk_bf16_f32 v176, v176, v177
    v_cvt_pk_bf16_f32 v177, v178, v179
    v_cvt_pk_bf16_f32 v178, v180, v181
    v_cvt_pk_bf16_f32 v179, v182, v183
    buffer_store_dwordx4 v[176:179], v1, s[24:27], s47 offen offset:2048 sc1
    v_accvgpr_read_b32 v184, a184
    v_accvgpr_read_b32 v185, a185
    v_accvgpr_read_b32 v186, a186
    v_accvgpr_read_b32 v187, a187
    v_accvgpr_read_b32 v188, a188
    v_accvgpr_read_b32 v189, a189
    v_accvgpr_read_b32 v190, a190
    v_accvgpr_read_b32 v191, a191
    v_cvt_pk_bf16_f32 v184, v184, v185
    v_cvt_pk_bf16_f32 v185, v186, v187
    v_cvt_pk_bf16_f32 v186, v188, v189
    v_cvt_pk_bf16_f32 v187, v190, v191
    buffer_store_dwordx4 v[184:187], v1, s[24:27], s47 offen offset:3072 sc1
    s_mov_b32 s76, s90
    s_mov_b32 s77, s91
    s_mov_b32 s78, 256
    s_mov_b32 s79, 0x20000
    s_mov_b32 s80, s88
    s_mov_b32 s81, s89
    s_mov_b32 s82, 1179648
    s_mov_b32 s83, 0x20000
    s_lshl_b32 s52, s93, 2
    v_mov_b32 v32, 0
    v_mov_b32 v33, 1
    v_mov_b32 v34, 1
    v_mov_b32 v35, 131072
    s_mov_b32 s57, 0
    v_lshrrev_b32 v36, 4, v1
    v_and_b32 v37, 31, v36
    v_mul_u32_u24 v37, 1152, v37
    v_lshrrev_b32 v36, 5, v36
    v_lshl_add_u32 v37, v36, 4, v37
    s_lshl_b32 s94, 1, s92
    v_lshlrev_b32 v38, 3, v1
    s_lshl_b32 s35, s28, 8
    s_lshl_b32 s36, s92, 2
    s_add_u32 s35, s35, s36
    v_lshrrev_b32 v39, 2, v1
    s_lshl_b32 s53, s92, 7
    s_mov_b64 exec, 3
    s_waitcnt vmcnt(0)
    buffer_store_dword v33, v38, s[96:99], s35 offen sc1
    s_mov_b64 exec, -1
    s_barrier
    s_cmp_lg_u32 s28, 1
    s_cbranch_scc1 L_f_w0
    s_mov_b64 exec, 1
    buffer_atomic_add v34, v32, s[76:79], s52 offen sc0
    s_mov_b64 exec, -1
L_f_w0:
    s_cmp_lg_u32 s28, 0
    s_cbranch_scc1 L_f_join
    s_mov_b32 s95, 600
    s_mov_b64 exec, 0xff
L_f_poll:
    buffer_load_dword v33, v39, s[96:99], s53 offen sc1
    s_sub_u32 s95, s95, 1
    s_waitcnt vmcnt(0)
    v_cmp_ne_u32 vcc, 1, v33
    s_cbranch_vccz L_f_pub
    s_sleep 1
    s_cmp_lg_u32 s95, 0
    s_cbranch_scc1 L_f_poll
    s_mov_b64 exec, 1
    s_lshl_b32 s35, s94, 8
    v_mov_b32 v33, s35
    buffer_atomic_or v33, v32, s[76:79], s52 offen sc0
    s_waitcnt vmcnt(0)
    v_readfirstlane_b32 s35, v33
    s_nop 3
    s_and_b32 s35, s35, 0xff
    s_cmp_eq_u32 s35, 8
    s_cselect_b32 s94, s94, 0
L_f_pub:
    v_mov_b32 v33, s94
    ds_write_b32 v35, v33
    s_mov_b64 exec, -1
    s_waitcnt lgkmcnt(0)
L_f_join:
    s_barrier
    ds_read_b32 v33, v35
    s_mul_i32 s93, s93, 36864
    s_waitcnt lgkmcnt(0)
    v_readfirstlane_b32 s94, v33
    s_nop 3
L_f_loop:
    s_cmp_eq_u32 s94, 0
    s_cbranch_scc1 L_f_end
    s_ff1_i32_b32 s92, s94
    s_bitset0_b32 s94, s92
    s_lshr_b32 s52, s92, 1
    s_and_b32 s53, s92, 1
    s_mul_i32 s95, s52, 9216
    s_lshl_b32 s36, s53, 2
    s_add_u32 s36, s36, s28
    s_lshl_b32 s35, s36, 10
    s_add_u32 s35, s35, s95
    buffer_load_dwordx4 v[128:131], v1, s[24:27], s35 offen sc1
    s_add_u32 s35, s35, 36864
    buffer_load_dwordx4 v[132:135], v1, s[24:27], s35 offen sc1
    s_add_u32 s35, s35, 36864
    buffer_load_dwordx4 v[136:139], v1, s[24:27], s35 offen sc1
    s_add_u32 s35, s35, 36864
    buffer_load_dwordx4 v[140:143], v1, s[24:27], s35 offen sc1
    s_add_u32 s35, s35, 36864
    buffer_load_dwordx4 v[144:147], v1, s[24:27], s35 offen sc1
    s_add_u32 s35, s35, 36864
    buffer_load_dwordx4 v[148:151], v1, s[24:27], s35 offen sc1
    s_add_u32 s35, s35, 36864
    buffer_load_dwordx4 v[152:155], v1, s[24:27], s35 offen sc1
    s_add_u32 s35, s35, 36864
    buffer_load_dwordx4 v[156:159], v1, s[24:27], s35 offen sc1
    s_cmp_lg_u32 s36, 3
    s_cbranch_scc1 L_f_nox
    s_add_u32 s35, s95, 8192
    buffer_load_dwordx4 v[192:195], v1, s[24:27], s35 offen sc1
    s_add_u32 s35, s35, 36864
    buffer_load_dwordx4 v[196:199], v1, s[24:27], s35 offen sc1
    s_add_u32 s35, s35, 36864
    buffer_load_dwordx4 v[200:203], v1, s[24:27], s35 offen sc1
    s_add_u32 s35, s35, 36864
    buffer_load_dwordx4 v[204:207], v1, s[24:27], s35 offen sc1
    s_add_u32 s35, s35, 36864
    buffer_load_dwordx4 v[208:211], v1, s[24:27], s35 offen sc1
    s_add_u32 s35, s35, 36864
    buffer_load_dwordx4 v[212:215], v1, s[24:27], s35 offen sc1
    s_add_u32 s35, s35, 36864
    buffer_load_dwordx4 v[216:219], v1, s[24:27], s35 offen sc1
    s_add_u32 s35, s35, 36864
    buffer_load_dwordx4 v[220:223], v1, s[24:27], s35 offen sc1
    s_lshl_b32 s35, s52, 5
    s_add_u32 s35, s35, 1024
    s_add_u32 s35, s35, s93
    s_waitcnt vmcnt(0)
    v_lshlrev_b32 v224, 16, v192
    v_and_b32 v225, 0xffff0000, v192
    v_lshlrev_b32 v226, 16, v193
    v_and_b32 v227, 0xffff0000, v193
    v_lshlrev_b32 v228, 16, v194
    v_and_b32 v229, 0xffff0000, v194
    v_lshlrev_b32 v230, 16, v195
    v_and_b32 v231, 0xffff0000, v195
    v_lshlrev_b32 v240, 16, v196
    v_and_b32 v241, 0xffff0000, v196
    v_lshlrev_b32 v242, 16, v197
    v_and_b32 v243, 0xffff0000, v197
    v_lshlrev_b32 v244, 16, v198
    v_and_b32 v245, 0xffff0000, v198
    v_lshlrev_b32 v246, 16, v199
    v_and_b32 v247, 0xffff0000, v199
    v_pk_add_f32 v[224:225], v[224:225], v[240:241]
    v_pk_add_f32 v[226:227], v[226:227], v[242:243]
    v_pk_add_f32 v[228:229], v[228:229], v[244:245]
    v_pk_add_f32 v[230:231], v[230:231], v[246:247]
    v_lshlrev_b32 v232, 16, v200
    v_and_b32 v233, 0xffff0000, v200
    v_lshlrev_b32 v234, 16, v201
    v_and_b32 v235, 0xffff0000, v201
    v_lshlrev_b32 v236, 16, v202
    v_and_b32 v237, 0xffff0000, v202
    v_lshlrev_b32 v238, 16, v203
    v_and_b32 v239, 0xffff0000, v203
    v_pk_add_f32 v[224:225], v[224:225], v[232:233]
    v_pk_add_f32 v[226:227], v[226:227], v[234:235]
    v_pk_add_f32 v[228:229], v[228:229], v[236:237]
    v_pk_add_f32 v[230:231], v[230:231], v[238:239]
    v_lshlrev_b32 v240, 16, v204
    v_and_b32 v241, 0xffff0000, v204
    v_lshlrev_b32 v242, 16, v205
    v_and_b32 v243, 0xffff0000, v205
    v_lshlrev_b32 v244, 16, v206
    v_and_b32 v245, 0xffff0000, v206
    v_lshlrev_b32 v246, 16, v207
    v_and_b32 v247, 0xffff0000, v207
    v_pk_add_f32 v[224:225], v[224:225], v[240:241]
    v_pk_add_f32 v[226:227], v[226:227], v[242:243]
    v_pk_add_f32 v[228:229], v[228:229], v[244:245]
    v_pk_add_f32 v[230:231], v[230:231], v[246:247]
    v_lshlrev_b32 v232, 16, v208
    v_and_b32 v233, 0xffff0000, v208
    v_lshlrev_b32 v234, 16, v209
    v_and_b32 v235, 0xffff0000, v209
    v_lshlrev_b32 v236, 16, v210
    v_and_b32 v237, 0xffff0000, v210
    v_lshlrev_b32 v238, 16, v211
    v_and_b32 v239, 0xffff0000, v211
    v_pk_add_f32 v[224:225], v[224:225], v[232:233]
    v_pk_add_f32 v[226:227], v[226:227], v[234:235]
    v_pk_add_f32 v[228:229], v[228:229], v[236:237]
    v_pk_add_f32 v[230:231], v[230:231], v[238:239]
    v_lshlrev_b32 v240, 16, v212
    v_and_b32 v241, 0xffff0000, v212
    v_lshlrev_b32 v242, 16, v213
    v_and_b32 v243, 0xffff0000, v213
    v_lshlrev_b32 v244, 16, v214
    v_and_b32 v245, 0xffff0000, v214
    v_lshlrev_b32 v246, 16, v215
    v_and_b32 v247, 0xffff0000, v215
    v_pk_add_f32 v[224:225], v[224:225], v[240:241]
    v_pk_add_f32 v[226:227], v[226:227], v[242:243]
    v_pk_add_f32 v[228:229], v[228:229], v[244:245]
    v_pk_add_f32 v[230:231], v[230:231], v[246:247]
    v_lshlrev_b32 v232, 16, v216
    v_and_b32 v233, 0xffff0000, v216
    v_lshlrev_b32 v234, 16, v217
    v_and_b32 v235, 0xffff0000, v217
    v_lshlrev_b32 v236, 16, v218
    v_and_b32 v237, 0xffff0000, v218
    v_lshlrev_b32 v238, 16, v219
    v_and_b32 v239, 0xffff0000, v219
    v_pk_add_f32 v[224:225], v[224:225], v[232:233]
    v_pk_add_f32 v[226:227], v[226:227], v[234:235]
    v_pk_add_f32 v[228:229], v[228:229], v[236:237]
    v_pk_add_f32 v[230:231], v[230:231], v[238:239]
    v_lshlrev_b32 v240, 16, v220
    v_and_b32 v241, 0xffff0000, v220
    v_lshlrev_b32 v242, 16, v221
    v_and_b32 v243, 0xffff0000, v221
    v_lshlrev_b32 v244, 16, v222
    v_and_b32 v245, 0xffff0000, v222
    v_lshlrev_b32 v246, 16, v223
    v_and_b32 v247, 0xffff0000, v223
    v_pk_add_f32 v[224:225], v[224:225], v[240:241]
    v_pk_add_f32 v[226:227], v[226:227], v[242:243]
    v_pk_add_f32 v[228:229], v[228:229], v[244:245]
    v_pk_add_f32 v[230:231], v[230:231], v[246:247]
    v_cvt_pk_bf16_f32 v192, v224, v225
    v_cvt_pk_bf16_f32 v193, v226, v227
    v_cvt_pk_bf16_f32 v194, v228, v229
    v_cvt_pk_bf16_f32 v195, v230, v231
    buffer_store_dwordx4 v[192:195], v37, s[80:83], s35 offen
L_f_nox:
    s_lshr_b32 s35, s36, 1
    s_xor_b32 s35, s35, s52
    s_lshl_b32 s35, s35, 6
    s_lshl_b32 s52, s52, 8
    s_add_u32 s35, s35, s52
    s_and_b32 s36, s36, 1
    s_lshl_b32 s36, s36, 5
    s_add_u32 s35, s35, s36
    s_add_u32 s35, s35, s93
    s_waitcnt vmcnt(7)
    v_lshlrev_b32 v160, 16, v128
    v_and_b32 v161, 0xffff0000, v128
    v_lshlrev_b32 v162, 16, v129
    v_and_b32 v163, 0xffff0000, v129
    v_lshlrev_b32 v164, 16, v130
    v_and_b32 v165, 0xffff0000, v130
    v_lshlrev_b32 v166, 16, v131
    v_and_b32 v167, 0xffff0000, v131
    s_waitcnt vmcnt(6)
    v_lshlrev_b32 v176, 16, v132
    v_and_b32 v177, 0xffff0000, v132
    v_lshlrev_b32 v178, 16, v133
    v_and_b32 v179, 0xffff0000, v133
    v_lshlrev_b32 v180, 16, v134
    v_and_b32 v181, 0xffff0000, v134
    v_lshlrev_b32 v182, 16, v135
    v_and_b32 v183, 0xffff0000, v135
    v_pk_add_f32 v[160:161], v[160:161], v[176:177]
    v_pk_add_f32 v[162:163], v[162:163], v[178:179]
    v_pk_add_f32 v[164:165], v[164:165], v[180:181]
    v_pk_add_f32 v[166:167], v[166:167], v[182:183]
    s_waitcnt vmcnt(5)
    v_lshlrev_b32 v168, 16, v136
    v_and_b32 v169, 0xffff0000, v136
    v_lshlrev_b32 v170, 16, v137
    v_and_b32 v171, 0xffff0000, v137
    v_lshlrev_b32 v172, 16, v138
    v_and_b32 v173, 0xffff0000, v138
    v_lshlrev_b32 v174, 16, v139
    v_and_b32 v175, 0xffff0000, v139
    v_pk_add_f32 v[160:161], v[160:161], v[168:169]
    v_pk_add_f32 v[162:163], v[162:163], v[170:171]
    v_pk_add_f32 v[164:165], v[164:165], v[172:173]
    v_pk_add_f32 v[166:167], v[166:167], v[174:175]
    s_waitcnt vmcnt(4)
    v_lshlrev_b32 v176, 16, v140
    v_and_b32 v177, 0xffff0000, v140
    v_lshlrev_b32 v178, 16, v141
    v_and_b32 v179, 0xffff0000, v141
    v_lshlrev_b32 v180, 16, v142
    v_and_b32 v181, 0xffff0000, v142
    v_lshlrev_b32 v182, 16, v143
    v_and_b32 v183, 0xffff0000, v143
    v_pk_add_f32 v[160:161], v[160:161], v[176:177]
    v_pk_add_f32 v[162:163], v[162:163], v[178:179]
    v_pk_add_f32 v[164:165], v[164:165], v[180:181]
    v_pk_add_f32 v[166:167], v[166:167], v[182:183]
    s_waitcnt vmcnt(3)
    v_lshlrev_b32 v168, 16, v144
    v_and_b32 v169, 0xffff0000, v144
    v_lshlrev_b32 v170, 16, v145
    v_and_b32 v171, 0xffff0000, v145
    v_lshlrev_b32 v172, 16, v146
    v_and_b32 v173, 0xffff0000, v146
    v_lshlrev_b32 v174, 16, v147
    v_and_b32 v175, 0xffff0000, v147
    v_pk_add_f32 v[160:161], v[160:161], v[168:169]
    v_pk_add_f32 v[162:163], v[162:163], v[170:171]
    v_pk_add_f32 v[164:165], v[164:165], v[172:173]
    v_pk_add_f32 v[166:167], v[166:167], v[174:175]
    s_waitcnt vmcnt(2)
    v_lshlrev_b32 v176, 16, v148
    v_and_b32 v177, 0xffff0000, v148
    v_lshlrev_b32 v178, 16, v149
    v_and_b32 v179, 0xffff0000, v149
    v_lshlrev_b32 v180, 16, v150
    v_and_b32 v181, 0xffff0000, v150
    v_lshlrev_b32 v182, 16, v151
    v_and_b32 v183, 0xffff0000, v151
    v_pk_add_f32 v[160:161], v[160:161], v[176:177]
    v_pk_add_f32 v[162:163], v[162:163], v[178:179]
    v_pk_add_f32 v[164:165], v[164:165], v[180:181]
    v_pk_add_f32 v[166:167], v[166:167], v[182:183]
    s_waitcnt vmcnt(1)
    v_lshlrev_b32 v168, 16, v152
    v_and_b32 v169, 0xffff0000, v152
    v_lshlrev_b32 v170, 16, v153
    v_and_b32 v171, 0xffff0000, v153
    v_lshlrev_b32 v172, 16, v154
    v_and_b32 v173, 0xffff0000, v154
    v_lshlrev_b32 v174, 16, v155
    v_and_b32 v175, 0xffff0000, v155
    v_pk_add_f32 v[160:161], v[160:161], v[168:169]
    v_pk_add_f32 v[162:163], v[162:163], v[170:171]
    v_pk_add_f32 v[164:165], v[164:165], v[172:173]
    v_pk_add_f32 v[166:167], v[166:167], v[174:175]
    s_waitcnt vmcnt(0)
    v_lshlrev_b32 v176, 16, v156
    v_and_b32 v177, 0xffff0000, v156
    v_lshlrev_b32 v178, 16, v157
    v_and_b32 v179, 0xffff0000, v157
    v_lshlrev_b32 v180, 16, v158
    v_and_b32 v181, 0xffff0000, v158
    v_lshlrev_b32 v182, 16, v159
    v_and_b32 v183, 0xffff0000, v159
    v_pk_add_f32 v[160:161], v[160:161], v[176:177]
    v_pk_add_f32 v[162:163], v[162:163], v[178:179]
    v_pk_add_f32 v[164:165], v[164:165], v[180:181]
    v_pk_add_f32 v[166:167], v[166:167], v[182:183]
    v_cvt_pk_bf16_f32 v128, v160, v161
    v_cvt_pk_bf16_f32 v129, v162, v163
    v_cvt_pk_bf16_f32 v130, v164, v165
    v_cvt_pk_bf16_f32 v131, v166, v167
    buffer_store_dwordx4 v[128:131], v37, s[80:83], s35 offen
    s_nop 1
    s_branch L_f_loop
L_f_end:
    s_cmp_lg_u32 s57, 0
    s_cbranch_scc1 L_f_out
    s_mov_b32 s57, 1
    s_cmp_lg_u32 s28, 1
    s_cbranch_scc1 L_f_j2
    s_waitcnt vmcnt(0)
    v_readfirstlane_b32 s35, v34
    s_nop 3
    s_lshr_b32 s36, s35, 8
    s_and_b32 s36, s36, 0xff
    s_and_b32 s35, s35, 0xff
    s_cmp_eq_u32 s35, 7
    s_cselect_b32 s36, s36, 0
    v_mov_b32 v33, s36
    ds_write_b32 v35, v33 offset:64
    s_waitcnt lgkmcnt(0)
L_f_j2:
    s_barrier
    ds_read_b32 v33, v35 offset:64
    s_waitcnt lgkmcnt(0)
    v_readfirstlane_b32 s94, v33
    s_nop 3
    s_branch L_f_loop
L_f_out:
L_done:
    s_endpgm
.section .rodata,"a"
.p2align 6
.amdhsa_kernel standalone__gqa_block_cached__sampling_kernel
  .amdhsa_next_free_vgpr 512
  .amdhsa_next_free_sgpr 102
  .amdhsa_accum_offset 256
  .amdhsa_group_segment_fixed_size 0
  .amdhsa_kernarg_size 64
  .amdhsa_user_sgpr_count 2
  .amdhsa_user_sgpr_kernarg_segment_ptr 1
  .amdhsa_system_sgpr_workgroup_id_x 1
  .amdhsa_float_denorm_mode_32 3
  .amdhsa_float_denorm_mode_16_64 3
.end_amdhsa_kernel
```
